```python
import torch

def _softmax(x, axis=-1):
    return torch.softmax(x, dim=axis)
def _gelu(x):
    return torch.nn.functional.gelu(x, approximate="tanh")
def _silu(x):
    return torch.nn.functional.silu(x)
def _sigmoid(x):
    return torch.sigmoid(x)
def _layernorm(x, axis=-1, eps=1e-5):
    m = x.mean(dim=axis, keepdim=True)
    v = x.var(dim=axis, keepdim=True, unbiased=False)
    return (x - m) / torch.sqrt(v + eps)
def _scatter_add(tgt, idx, src, axis=0):
    return tgt.clone().index_add_(axis, idx, src)
def _segment_sum(src, seg, n):
    out = torch.zeros((n,) + src.shape[1:], dtype=src.dtype)
    return out.index_add_(0, seg, src)
def _pad(x, pw):
    flat = tuple(v for pair in reversed(pw) for v in pair)
    return torch.nn.functional.pad(x, flat)

kernel_name = 'standalone__edge_featured_mpnn_mpnn__graph'

def setup_inputs():

    _w = (lambda a: (lambda t: t.to(torch.bfloat16) if t.is_floating_point() else t)(torch.as_tensor(a)))
    N, deg, D, De = 12500, 64, 64, max(0, 1)
    E = N * deg
    H = 2 * D
    return {
        "x": _w((lambda *s: torch.randn(*s, dtype=torch.bfloat16) * 0.05)(N, D)),
        "e_attr": _w((lambda *s: torch.randn(*s, dtype=torch.bfloat16) * 1.6)(E, De)),
        "src": _w((lambda lo, hi, *s: torch.randint(lo, hi, s))(0, N, E).to(torch.int64)),
        "dst": _w((lambda lo, hi, *s: torch.randint(lo, hi, s))(0, N, E).to(torch.int64)),
        "w1": _w((lambda *s: torch.randn(*s, dtype=torch.bfloat16) * 1.6)(2 * D + De, H) * (1.0 / (2 * D + De) ** 0.5)),
        "b1": _w((lambda *s: torch.randn(*s, dtype=torch.bfloat16) * 1.6)(H) * 0.01),
        "w2": _w((lambda *s: torch.randn(*s, dtype=torch.bfloat16) * 0.05)(H, D) * (1.0 / H ** 0.5)),
        "b2": _w((lambda *s: torch.randn(*s, dtype=torch.bfloat16) * 0.05)(D) * 0.01),
    }

def reference(x, e_attr, src, dst, w1, b1, w2, b2):
    N, D = x.shape
    h_src = x[src]
    h_dst = x[dst]
    m_in = torch.concatenate([h_src, h_dst, e_attr], axis=-1)
    h = _silu(m_in @ w1 + b1)
    msg = h @ w2 + b2
    return _segment_sum(msg, dst, N)
```

```asm
; @launch grid=(256,1,1) block=(512,1,1) lds=160288
.amdgcn_target "amdgcn-amd-amdhsa--gfx950"
.text
.globl standalone__edge_featured_mpnn_mpnn__graph_kernel
.p2align 12
.p2align 8
.type standalone__edge_featured_mpnn_mpnn__graph_kernel,@function
standalone__edge_featured_mpnn_mpnn__graph_kernel:
    s_cmpk_ge_u32 s2, 256
    s_cbranch_scc1 K_END
    s_load_dwordx2 s[20:21], s[0:1], 24
    s_load_dwordx2 s[8:9], s[0:1], 0
    s_load_dwordx2 s[24:25], s[0:1], 32
    s_load_dwordx2 s[44:45], s[0:1], 80
    s_load_dwordx2 s[16:17], s[0:1], 16
    s_load_dwordx2 s[12:13], s[0:1], 8
    s_getpc_b64 s[90:91]
CPF_PC:
    s_and_b32 s5, s2, -8
    v_subrev_u32_e64 v18, 56, v0
    v_add_lshl_u32 v16, v18, s5, 7
    v_add_u32 v16, 256, v16
    v_min_u32 v16, CODE_REST, v16
    v_mov_b32 v17, s91
    v_add_co_u32 v16, vcc, s90, v16
    v_cmp_gt_u32 s[76:77], 8, v18
    s_nop 0
    v_addc_co_u32 v17, vcc, 0, v17, vcc
    s_mov_b64 exec, s[76:77]
    s_cbranch_execz CPF_E
    global_load_dword v18, v[16:17], off
CPF_E:
    s_mov_b64 exec, -1
    v_readfirstlane_b32 s4, v0
    v_and_b32 v14, 63, v0
    v_mov_b32 v88, 0
    v_mov_b32 v89, 0
    v_lshlrev_b32 v92, 3, v0
    ds_write_b64 v92, v[88:89]
    s_mov_b32 s23, 0x00020000
    s_mov_b32 s22, 3200000
    s_mov_b32 s10, 1600000
    s_mov_b32 s11, s23
    s_mov_b32 s26, 33024
    s_mov_b32 s27, s23
    s_lshr_b32 s4, s4, 6
    s_and_b32 s3, s2, 7
    s_lshl_b32 s3, s3, 5
    s_lshr_b32 s5, s2, 3
    s_add_u32 s3, s3, s5
    s_mul_i32 s5, s2, 12512
    v_lshl_add_u32 v32, v0, 4, s5
    s_cmpk_eq_u32 s2, 255
    s_movk_i32 s6, 270
    s_cmovk_i32 s6, 78
    v_cmp_gt_u32 s[74:75], s6, v0
    v_lshrrev_b32 v37, 4, v14
    v_lshrrev_b32 v47, 3, v14
    v_and_b32 v48, 7, v14
    v_and_b32 v45, 1, v37
    v_and_b32 v58, 4, v47
    v_and_b32 v59, 1, v47
    v_lshl_add_u32 v58, v59, 1, v58
    v_add_u32 v58, v58, v45
    v_xor_b32 v59, v48, v37
    v_lshlrev_b32 v59, 4, v59
    v_lshl_add_u32 v58, v58, 15, v59
    s_lshl_b32 s85, s4, 11
    s_add_u32 s5, s85, s3
    s_lshl_b32 s5, s5, 7
    v_add_u32_e64 v58, s5, v58
    v_lshlrev_b32_e64 v31, 2, v37
    v_xor_b32_e64 v31, v31, v14
    v_lshlrev_b32 v31, 4, v31
    s_mul_i32 s84, s4, 1088
    s_add_u32 m0, s84, 64000
    s_movk_i32 s86, 8192
    s_mov_b32 s18, s22
    s_mov_b32 s19, s23
    s_mov_b32 s14, s10
    s_mov_b32 s15, s23
    v_lshrrev_b32_e64 v34, 1, v32
    s_lshr_b32 s84, s86, 1
    s_waitcnt lgkmcnt(0)
    buffer_load_dwordx4 v[64:67], v32, s[20:23], 0 offen
    s_mov_b64 exec, s[74:75]
    s_cbranch_execz P0_ND
    buffer_load_dwordx4 v[68:71], v32, s[20:23], s86 offen
P0_ND:
    s_mov_b64 exec, -1
    s_barrier
    buffer_load_dwordx4 v58, s[8:11], 0 offen lds
    s_add_u32 m0, s85, 31232
    s_load_dwordx2 s[78:79], s[44:45], 0
    buffer_load_dwordx4 v31, s[24:27], s85 offen offset:0 lds
    buffer_load_dwordx4 v31, s[24:27], s85 offen offset:1024 lds
P0_ISS:
    s_load_dwordx2 s[28:29], s[0:1], 40
    s_load_dwordx2 s[92:93], s[0:1], 48
    s_load_dwordx2 s[36:37], s[0:1], 56
    s_load_dwordx2 s[40:41], s[0:1], 64
    v_mov_b32_e64 v13, v0
    s_mov_b32 s30, 256
    s_mov_b32 s31, s23
    s_mov_b32 s94, 16384
    s_mov_b32 s95, s23
    s_mov_b32 s38, 128
    s_mov_b32 s39, s23
    s_mov_b32 s46, 9017472
    s_mov_b32 s47, s23
    s_mov_b32 s42, 1600000
    s_mov_b32 s43, s23
    s_mov_b32 s50, 12544
    s_mov_b32 s51, s23
    s_mov_b32 s80, 0xbfb8aa3b
    s_mov_b32 s81, s80
    v_lshrrev_b32 v38, 5, v14
    v_and_b32 v39, 31, v14
    v_bfe_u32 v40, v39, 2, 1
    v_and_b32 v41, 1, v39
    v_lshl_add_u32 v40, v40, 1, v41
    v_lshrrev_b32_e64 v42, 3, v39
    v_bfe_u32 v43, v39, 1, 1
    v_bfe_u32 v44, v14, 2, 2
    v_and_b32 v46, 3, v14
    v_lshlrev_b32 v46, 3, v46
    v_lshl_add_u32 v46, v45, 5, v46
    s_and_b32 s82, s4, 3
    s_lshr_b32 s83, s4, 2
    v_xor_b32_e64 v50, s82, v44
    v_lshl_add_u32 v50, v50, 6, v46
    v_lshl_add_u32 v51, v38, 3, v44
    v_lshl_add_u32 v50, v51, 8, v50
    v_lshl_add_u32 v51, v40, 1, v43
    v_mul_u32_u24 v52, 1088, v42
    v_lshl_add_u32 v52, v51, 7, v52
    s_mul_i32 s5, s83, 4352
    s_add_u32 s5, s5, 64000
    v_add_u32 v52, s5, v52
    v_xor_b32 v53, v38, v40
    v_lshl_add_u32 v51, v53, 4, v52
    v_xor_b32 v53, 2, v53
    v_lshl_add_u32 v52, v53, 4, v52
    s_lshl_b32 s5, s83, 5
    v_add_u32 v55, s5, v39
    v_cmp_gt_u32 s[88:89], 49, v55
    s_lshl_b32 s82, s82, 6
    v_lshl_add_u32 v49, v38, 3, s82
    v_add_u32 v56, 101376, v49
    v_mul_u32_u24 v53, 272, v55
    v_add_u32_e64 v53, v53, v56
    v_mul_u32_u24 v54, 328, v55
    v_add_u32 v54, v54, v56
    s_mov_b32 s7, 101376
    v_lshlrev_b32 v61, 4, v0
    v_and_b32_e64 v56, -16, v0
    v_add3_u32 v62, v61, v56, s7
    s_min_u32 s5, s4, 2
    s_lshl2_add_u32 s5, s4, s5
    s_add_u32 s5, s5, 64
    s_lshl_b32 s5, s5, 3
    v_add_u32 v55, s5, v14
    v_lshlrev_b32 v63, 4, v55
    v_and_b32 v56, -16, v55
    v_add3_u32 v22, v63, v56, s7
    s_cmp_lt_u32 s4, 2
    s_cselect_b32 s71, 40, 32
    v_lshlrev_b32 v92, 4, v13
    v_add_u32 v93, 133888, v92
    v_mov_b32 v84, 0xf000
    v_mov_b32 v85, 0xf000
    v_mov_b32 v86, 0xf000
    v_mov_b32 v87, 0xf000
    ds_write_b128 v93, v[84:87] offset:0
    ds_write_b128 v93, v[84:87] offset:8192
    ds_write_b128 v93, v[84:87] offset:16384
    ds_write_b128 v93, v[84:87] offset:18208
    v_mov_b32 v88, 0
    v_mov_b32 v89, 0
    v_mov_b32 v90, 0
    v_mov_b32 v91, 0
    v_add_u32 v92, 73728, v92
    ds_write_b128 v92, v[88:91] offset:0
    ds_write_b128 v92, v[88:91] offset:8192
    ds_write_b128 v92, v[88:91] offset:16384
    v_min_u32 v92, 383, v13
    v_lshlrev_b32_e64 v92, 3, v92
    v_add_u32 v92, 98304, v92
    v_mov_b32 v94, 25872
    v_mov_b32 v95, 25872
    ds_write_b64 v92, v[94:95]
    s_mul_i32 s6, s3, 12544
    s_add_u32 s6, s6, 4096
    s_mov_b32 s87, 32768
    v_mov_b32_e64 v55, 1
    s_mov_b32 s70, 0xffff0000
    v_lshlrev_b32 v36, 2, v14
    v_lshlrev_b32 v58, 4, v14
    v_lshlrev_b32_e64 v23, 1, v14
    buffer_load_dwordx4 v[72:75], v32, s[16:19], 0 offen
    buffer_load_dwordx2 v[80:81], v34, s[12:15], 0 offen
    s_mov_b64 exec, s[74:75]
    s_cbranch_execz P0_NS
    buffer_load_dwordx4 v[76:79], v32, s[16:19], s86 offen
    buffer_load_dwordx2 v[82:83], v34, s[12:15], s84 offen
P0_NS:
    s_mov_b64 exec, -1
    s_mov_b64 exec, s[74:75]
    s_cbranch_execz P1_A
    s_waitcnt vmcnt(7)
    v_lshlrev_b32_sdwa v116, 2, v68 dst_sel:DWORD dst_unused:UNUSED_PAD src0_sel:DWORD src1_sel:BYTE_0
    ds_add_rtn_u32 v124, v116, v55 offset:0
    v_lshlrev_b32_sdwa v117, 2, v69 dst_sel:DWORD dst_unused:UNUSED_PAD src0_sel:DWORD src1_sel:BYTE_0
    ds_add_rtn_u32 v125, v117, v55 offset:0
    v_lshlrev_b32_sdwa v118, 2, v70 dst_sel:DWORD dst_unused:UNUSED_PAD src0_sel:DWORD src1_sel:BYTE_0
    ds_add_rtn_u32 v126, v118, v55 offset:0
    v_lshlrev_b32_sdwa v119, 2, v71 dst_sel:DWORD dst_unused:UNUSED_PAD src0_sel:DWORD src1_sel:BYTE_0
    ds_add_rtn_u32 v127, v119, v55 offset:0
    s_mov_b64 exec, -1
    s_branch P1_A1
P1_A:
    s_mov_b64 exec, -1
    s_waitcnt vmcnt(5)
P1_A1:
    v_lshlrev_b32_sdwa v112, 2, v64 dst_sel:DWORD dst_unused:UNUSED_PAD src0_sel:DWORD src1_sel:BYTE_0
    ds_add_rtn_u32 v120, v112, v55 offset:0
    v_lshlrev_b32_sdwa v113, 2, v65 dst_sel:DWORD dst_unused:UNUSED_PAD src0_sel:DWORD src1_sel:BYTE_0
    ds_add_rtn_u32 v121, v113, v55 offset:0
    v_lshlrev_b32_sdwa v114, 2, v66 dst_sel:DWORD dst_unused:UNUSED_PAD src0_sel:DWORD src1_sel:BYTE_0
    ds_add_rtn_u32 v122, v114, v55 offset:0
    v_lshlrev_b32_sdwa v115, 2, v67 dst_sel:DWORD dst_unused:UNUSED_PAD src0_sel:DWORD src1_sel:BYTE_0
    ds_add_rtn_u32 v123, v115, v55 offset:0
    s_cmp_eq_u64 s[74:75], 0
    s_waitcnt vmcnt(4)
    s_cbranch_scc0 P1_A2
    s_waitcnt vmcnt(2)
P1_A2:
    s_add_u32 s86, s85, 16384
    s_add_u32 m0, s86, 31232
    s_cmp_eq_u32 s4, 7
    s_waitcnt lgkmcnt(0)
    s_barrier
    s_cbranch_scc1 P1_SCAN
    ds_read_b64_tr_b16 v[88:89], v50 offset:31232
    ds_read_b64_tr_b16 v[90:91], v50 offset:32256
    ds_read_b128 v[160:163], v51 offset:0
    ds_read_b64_tr_b16 v[92:93], v50 offset:35328
    ds_read_b64_tr_b16 v[94:95], v50 offset:36352
    ds_read_b128 v[164:167], v52 offset:0
    ds_read_b64_tr_b16 v[96:97], v50 offset:39424
    ds_read_b64_tr_b16 v[98:99], v50 offset:40448
    ds_read_b128 v[168:171], v51 offset:64
    ds_read_b64_tr_b16 v[100:101], v50 offset:43520
    ds_read_b64_tr_b16 v[102:103], v50 offset:44544
    ds_read_b128 v[172:175], v52 offset:64
    s_waitcnt lgkmcnt(9)
    v_mfma_f32_32x32x16_bf16 v[144:159], v[88:91], v[160:163], 0
    s_waitcnt lgkmcnt(6)
    v_mfma_f32_32x32x16_bf16 v[144:159], v[92:95], v[164:167], v[144:159]
    s_waitcnt lgkmcnt(3)
    v_mfma_f32_32x32x16_bf16 v[144:159], v[96:99], v[168:171], v[144:159]
    s_waitcnt lgkmcnt(0)
    v_mfma_f32_32x32x16_bf16 v[144:159], v[100:103], v[172:175], v[144:159]
    s_mul_i32 s73, s78, 1664525
    s_add_u32 s73, s73, 1013904223
    s_add_u32 s72, s79, 0x01000000
    s_and_b32 s72, s72, 0xff000000
    s_cmp_eq_u32 s4, 6
    s_cbranch_scc0 P1_H6
    buffer_load_dword v20, v36, s[24:27], s87 offen
    buffer_load_ushort v21, v23, s[36:39], 0 offen
    buffer_load_dword v19, v36, s[28:31], 0 offen
P1_H6:
    s_nop 3
    s_branch P1_HJ
P1_SCAN:
    s_setprio 3
    ds_read_b128 v[136:139], v58 offset:0
    s_nop 0
    ds_read_b64_tr_b16 v[88:89], v50 offset:31232
    ds_read_b64_tr_b16 v[90:91], v50 offset:32256
    ds_read_b128 v[160:163], v51 offset:0
    ds_read_b64_tr_b16 v[92:93], v50 offset:35328
    ds_read_b64_tr_b16 v[94:95], v50 offset:36352
    ds_read_b128 v[164:167], v52 offset:0
    ds_read_b64_tr_b16 v[96:97], v50 offset:39424
    ds_read_b64_tr_b16 v[98:99], v50 offset:40448
    ds_read_b128 v[168:171], v51 offset:64
    ds_read_b64_tr_b16 v[100:101], v50 offset:43520
    ds_read_b64_tr_b16 v[102:103], v50 offset:44544
    ds_read_b128 v[172:175], v52 offset:64
    s_mul_i32 s73, s78, 1664525
    s_add_u32 s73, s73, 1013904223
    s_add_u32 s72, s79, 0x01000000
    s_and_b32 s72, s72, 0xff000000
    s_mul_i32 s7, s2, 2176
    s_add_u32 s7, s7, 3215360
    s_waitcnt lgkmcnt(0)
    v_mfma_f32_32x32x16_bf16 v[144:159], v[88:91], v[160:163], 0
    v_mfma_f32_32x32x16_bf16 v[144:159], v[92:95], v[164:167], v[144:159]
    v_mfma_f32_32x32x16_bf16 v[144:159], v[96:99], v[168:171], v[144:159]
    v_mfma_f32_32x32x16_bf16 v[144:159], v[100:103], v[172:175], v[144:159]
    v_add_u32 v116, 1, v136
    v_and_b32 v116, -2, v116
    v_add_u32 v117, 1, v137
    v_and_b32 v117, -2, v117
    v_add_u32 v118, 1, v138
    v_and_b32 v118, -2, v118
    v_add_u32 v119, 1, v139
    v_and_b32 v119, -2, v119
    v_add_u32 v57, v116, v117
    v_add_u32_e64 v56, v57, v118
    v_add_u32_e64 v59, v56, v119
    v_mov_b32 v60, v59
    s_nop 1
    v_add_u32_dpp v59, v59, v59 row_shr:1 row_mask:0xf bank_mask:0xf bound_ctrl:1
    s_nop 1
    v_add_u32_dpp v59, v59, v59 row_shr:2 row_mask:0xf bank_mask:0xf bound_ctrl:1
    s_nop 1
    v_add_u32_dpp v59, v59, v59 row_shr:4 row_mask:0xf bank_mask:0xf bound_ctrl:1
    s_nop 1
    v_add_u32_dpp v59, v59, v59 row_shr:8 row_mask:0xf bank_mask:0xf bound_ctrl:1
    s_nop 1
    v_add_u32_dpp v59, v59, v59 row_bcast:15 row_mask:0xa bank_mask:0xf
    s_nop 1
    v_add_u32_dpp v59, v59, v59 row_bcast:31 row_mask:0xc bank_mask:0xf
    v_sub_u32 v140, v59, v60
    v_add_u32 v141, v140, v116
    v_add_u32 v142, v140, v57
    v_add_u32_e64 v143, v140, v56
    ds_write_b128 v58, v[140:143] offset:1024
P1_HJ:
    buffer_load_dwordx4 v31, s[24:27], s86 offen offset:0 lds
    buffer_load_dwordx4 v31, s[24:27], s86 offen offset:1024 lds
    v_pk_mul_f32 v[144:145], v[144:145], s[80:81]
    v_pk_mul_f32 v[146:147], v[146:147], s[80:81]
    v_pk_mul_f32 v[148:149], v[148:149], s[80:81]
    v_pk_mul_f32 v[150:151], v[150:151], s[80:81]
    v_pk_mul_f32 v[152:153], v[152:153], s[80:81]
    v_pk_mul_f32 v[154:155], v[154:155], s[80:81]
    v_pk_mul_f32 v[156:157], v[156:157], s[80:81]
    v_pk_mul_f32 v[158:159], v[158:159], s[80:81]
    v_cvt_pk_bf16_f32 v88, v144, v145
    v_cvt_pk_bf16_f32 v89, v146, v147
    v_cvt_pk_bf16_f32 v90, v148, v149
    v_cvt_pk_bf16_f32 v91, v150, v151
    v_cvt_pk_bf16_f32 v92, v152, v153
    v_cvt_pk_bf16_f32 v93, v154, v155
    v_cvt_pk_bf16_f32 v94, v156, v157
    s_nop 0
    v_cvt_pk_bf16_f32 v95, v158, v159
    s_mov_b64 exec, s[88:89]
    ds_write_b64 v53, v[88:89] offset:0
    ds_write_b64 v53, v[90:91] offset:16
    ds_write_b64 v53, v[92:93] offset:32
    ds_write_b64 v53, v[94:95] offset:48
    s_mov_b64 exec, -1
    s_waitcnt lgkmcnt(0)
    s_barrier
    s_setprio 0
    ds_read_b128 v[104:107], v62
    ds_read_b128 v[108:111], v22
    ds_read_b32 v112, v112 offset:1024
    ds_read_b32 v113, v113 offset:1024
    ds_read_b32 v114, v114 offset:1024
    ds_read_b32 v115, v115 offset:1024
    s_waitcnt lgkmcnt(4)
    buffer_store_dwordx4 v[104:107], v61, s[44:47], s6 offen sc1
    s_bfm_b64 exec, s71, 0
    buffer_store_dwordx4 v[108:111], v63, s[44:47], s6 offen sc1
    s_mov_b64 exec, s[74:75]
    s_cbranch_execz P1_S1
    ds_read_b32 v116, v116 offset:1024
    ds_read_b32 v117, v117 offset:1024
    ds_read_b32 v118, v118 offset:1024
    ds_read_b32 v119, v119 offset:1024
    s_mov_b64 exec, -1
    s_waitcnt vmcnt(6)
    v_lshlrev_b32_sdwa v129, 2, v64 dst_sel:DWORD dst_unused:UNUSED_PAD src0_sel:DWORD src1_sel:BYTE_1
    v_mul_u32_u24_sdwa v57, 49, v72 dst_sel:DWORD dst_unused:UNUSED_PAD src0_sel:DWORD src1_sel:BYTE_0
    v_add_u32_sdwa v57, v57, v72 dst_sel:DWORD dst_unused:UNUSED_PAD src0_sel:DWORD src1_sel:BYTE_1
    v_lshl_or_b32 v128, v80, 16, v57
    v_lshlrev_b32_sdwa v131, 2, v65 dst_sel:DWORD dst_unused:UNUSED_PAD src0_sel:DWORD src1_sel:BYTE_1
    v_mul_u32_u24_sdwa v57, 49, v73 dst_sel:DWORD dst_unused:UNUSED_PAD src0_sel:DWORD src1_sel:BYTE_0
    v_add_u32_sdwa v57, v57, v73 dst_sel:DWORD dst_unused:UNUSED_PAD src0_sel:DWORD src1_sel:BYTE_1
    v_and_or_b32 v130, v80, s70, v57
    v_lshlrev_b32_sdwa v133, 2, v66 dst_sel:DWORD dst_unused:UNUSED_PAD src0_sel:DWORD src1_sel:BYTE_1
    v_mul_u32_u24_sdwa v57, 49, v74 dst_sel:DWORD dst_unused:UNUSED_PAD src0_sel:DWORD src1_sel:BYTE_0
    v_add_u32_sdwa v57, v57, v74 dst_sel:DWORD dst_unused:UNUSED_PAD src0_sel:DWORD src1_sel:BYTE_1
    v_lshl_or_b32 v132, v81, 16, v57
    v_lshlrev_b32_sdwa v135, 2, v67 dst_sel:DWORD dst_unused:UNUSED_PAD src0_sel:DWORD src1_sel:BYTE_1
    v_mul_u32_u24_sdwa v57, 49, v75 dst_sel:DWORD dst_unused:UNUSED_PAD src0_sel:DWORD src1_sel:BYTE_0
    v_add_u32_sdwa v57, v57, v75 dst_sel:DWORD dst_unused:UNUSED_PAD src0_sel:DWORD src1_sel:BYTE_1
    v_and_or_b32 v134, v81, s70, v57
    s_waitcnt lgkmcnt(0)
    v_add_lshl_u32 v112, v112, v120, 3
    s_nop 0
    ds_write_b64 v112, v[128:129] offset:4096
    v_add_lshl_u32 v113, v113, v121, 3
    ds_write_b64 v113, v[130:131] offset:4096
    v_add_lshl_u32 v114, v114, v122, 3
    ds_write_b64 v114, v[132:133] offset:4096
    v_add_lshl_u32 v115, v115, v123, 3
    ds_write_b64 v115, v[134:135] offset:4096
    s_mov_b64 exec, s[74:75]
    s_waitcnt vmcnt(4)
    v_lshlrev_b32_sdwa v137, 2, v68 dst_sel:DWORD dst_unused:UNUSED_PAD src0_sel:DWORD src1_sel:BYTE_1
    v_mul_u32_u24_sdwa v57, 49, v76 dst_sel:DWORD dst_unused:UNUSED_PAD src0_sel:DWORD src1_sel:BYTE_0
    v_add_u32_sdwa v57, v57, v76 dst_sel:DWORD dst_unused:UNUSED_PAD src0_sel:DWORD src1_sel:BYTE_1
    v_lshl_or_b32 v136, v82, 16, v57
    v_lshlrev_b32_sdwa v139, 2, v69 dst_sel:DWORD dst_unused:UNUSED_PAD src0_sel:DWORD src1_sel:BYTE_1
    v_mul_u32_u24_sdwa v57, 49, v77 dst_sel:DWORD dst_unused:UNUSED_PAD src0_sel:DWORD src1_sel:BYTE_0
    v_add_u32_sdwa v57, v57, v77 dst_sel:DWORD dst_unused:UNUSED_PAD src0_sel:DWORD src1_sel:BYTE_1
    v_and_or_b32 v138, v82, s70, v57
    v_lshlrev_b32_sdwa v141, 2, v70 dst_sel:DWORD dst_unused:UNUSED_PAD src0_sel:DWORD src1_sel:BYTE_1
    v_mul_u32_u24_sdwa v57, 49, v78 dst_sel:DWORD dst_unused:UNUSED_PAD src0_sel:DWORD src1_sel:BYTE_0
    v_add_u32_sdwa v57, v57, v78 dst_sel:DWORD dst_unused:UNUSED_PAD src0_sel:DWORD src1_sel:BYTE_1
    v_lshl_or_b32 v140, v83, 16, v57
    v_lshlrev_b32_sdwa v143, 2, v71 dst_sel:DWORD dst_unused:UNUSED_PAD src0_sel:DWORD src1_sel:BYTE_1
    v_mul_u32_u24_sdwa v57, 49, v79 dst_sel:DWORD dst_unused:UNUSED_PAD src0_sel:DWORD src1_sel:BYTE_0
    v_add_u32_sdwa v57, v57, v79 dst_sel:DWORD dst_unused:UNUSED_PAD src0_sel:DWORD src1_sel:BYTE_1
    v_and_or_b32 v142, v83, s70, v57
    v_add_lshl_u32 v116, v116, v124, 3
    ds_write_b64 v116, v[136:137] offset:4096
    v_add_lshl_u32 v117, v117, v125, 3
    ds_write_b64 v117, v[138:139] offset:4096
    v_add_lshl_u32 v118, v118, v126, 3
    ds_write_b64 v118, v[140:141] offset:4096
    v_add_lshl_u32 v119, v119, v127, 3
    ds_write_b64 v119, v[142:143] offset:4096
    s_mov_b64 exec, -1
    s_branch P1_JOIN
P1_S1:
    s_mov_b64 exec, -1
    s_cmp_eq_u32 s4, 7
    s_cbranch_scc0 P1_S2
    v_lshl_or_b32 v96, v136, 12, v140
    v_or_b32 v96, s72, v96
    v_mov_b32_e64 v97, s73
    v_lshl_or_b32 v98, v137, 12, v141
    v_or_b32_e64 v98, s72, v98
    v_mov_b32_e64 v99, s73
    v_lshl_or_b32 v100, v138, 12, v142
    v_or_b32_e64 v100, s72, v100
    v_mov_b32_e64 v101, s73
    v_lshl_or_b32 v102, v139, 12, v143
    v_or_b32_e64 v102, s72, v102
    v_mov_b32_e64 v103, s73
    buffer_store_dwordx4 v[96:99], v58, s[44:47], s7 offen sc1
    buffer_store_dwordx4 v[100:103], v58, s[44:47], s7 offen offset:1024 sc1
P1_S2:
    s_cmp_ge_u32 s4, 6
    s_waitcnt vmcnt(6)
    s_cbranch_scc1 P1_S3
    s_waitcnt vmcnt(4)
P1_S3:
    v_lshlrev_b32_sdwa v129, 2, v64 dst_sel:DWORD dst_unused:UNUSED_PAD src0_sel:DWORD src1_sel:BYTE_1
    v_mul_u32_u24_sdwa v57, 49, v72 dst_sel:DWORD dst_unused:UNUSED_PAD src0_sel:DWORD src1_sel:BYTE_0
    v_add_u32_sdwa v57, v57, v72 dst_sel:DWORD dst_unused:UNUSED_PAD src0_sel:DWORD src1_sel:BYTE_1
    v_lshl_or_b32 v128, v80, 16, v57
    v_lshlrev_b32_sdwa v131, 2, v65 dst_sel:DWORD dst_unused:UNUSED_PAD src0_sel:DWORD src1_sel:BYTE_1
    v_mul_u32_u24_sdwa v57, 49, v73 dst_sel:DWORD dst_unused:UNUSED_PAD src0_sel:DWORD src1_sel:BYTE_0
    v_add_u32_sdwa v57, v57, v73 dst_sel:DWORD dst_unused:UNUSED_PAD src0_sel:DWORD src1_sel:BYTE_1
    v_and_or_b32 v130, v80, s70, v57
    v_lshlrev_b32_sdwa v133, 2, v66 dst_sel:DWORD dst_unused:UNUSED_PAD src0_sel:DWORD src1_sel:BYTE_1
    v_mul_u32_u24_sdwa v57, 49, v74 dst_sel:DWORD dst_unused:UNUSED_PAD src0_sel:DWORD src1_sel:BYTE_0
    v_add_u32_sdwa v57, v57, v74 dst_sel:DWORD dst_unused:UNUSED_PAD src0_sel:DWORD src1_sel:BYTE_1
    v_lshl_or_b32 v132, v81, 16, v57
    v_lshlrev_b32_sdwa v135, 2, v67 dst_sel:DWORD dst_unused:UNUSED_PAD src0_sel:DWORD src1_sel:BYTE_1
    v_mul_u32_u24_sdwa v57, 49, v75 dst_sel:DWORD dst_unused:UNUSED_PAD src0_sel:DWORD src1_sel:BYTE_0
    v_add_u32_sdwa v57, v57, v75 dst_sel:DWORD dst_unused:UNUSED_PAD src0_sel:DWORD src1_sel:BYTE_1
    v_and_or_b32 v134, v81, s70, v57
    s_waitcnt lgkmcnt(0)
    v_add_lshl_u32 v112, v112, v120, 3
    s_nop 0
    ds_write_b64 v112, v[128:129] offset:4096
    v_add_lshl_u32 v113, v113, v121, 3
    ds_write_b64 v113, v[130:131] offset:4096
    v_add_lshl_u32 v114, v114, v122, 3
    ds_write_b64 v114, v[132:133] offset:4096
    v_add_lshl_u32 v115, v115, v123, 3
    ds_write_b64 v115, v[134:135] offset:4096
P1_JOIN:
    v_mul_u32_u24_e64 v60, 12, v13
    s_mul_i32 s5, s2, 20352
    s_add_u32 s5, s5, 3807232
    s_waitcnt lgkmcnt(0)
    s_barrier
    ds_read_b128 v[64:67], v61 offset:4096
    ds_read_b128 v[68:71], v61 offset:12288
    ds_read_b128 v[72:75], v61 offset:20480
    v_cmp_le_u32 vcc, 352, v13
    s_and_b64 exec, exec, vcc
    s_cbranch_execz P1_C
    ds_read_b128 v[76:79], v61 offset:23040
    s_add_u32 s7, s5, 14208
    s_waitcnt lgkmcnt(0)
    v_lshl_or_b32 v77, v79, 16, v77
    buffer_store_dwordx3 v[76:78], v60, s[44:47], s7 offen sc1
P1_C:
    s_mov_b64 exec, -1
    s_waitcnt lgkmcnt(2)
    v_lshl_or_b32 v65, v67, 16, v65
    buffer_store_dwordx3 v[64:66], v60, s[44:47], s5 offen sc1
    s_add_u32 s5, s5, 6144
    s_waitcnt lgkmcnt(1)
    v_lshl_or_b32 v69, v71, 16, v69
    buffer_store_dwordx3 v[68:70], v60, s[44:47], s5 offen sc1
    s_nop 0
    s_add_u32 s5, s5, 6144
    s_waitcnt lgkmcnt(0)
    v_lshl_or_b32 v73, v75, 16, v73
    buffer_store_dwordx3 v[72:74], v60, s[44:47], s5 offen sc1
    v_max_f32_e64 v56, |v144|, |v145|
    v_max3_f32 v56, |v146|, |v147|, v56
    v_max3_f32 v56, |v148|, |v149|, v56
    v_max3_f32 v56, |v150|, |v151|, v56
    v_max3_f32 v56, |v152|, |v153|, v56
    v_max3_f32 v56, |v154|, |v155|, v56
    v_max3_f32 v56, |v156|, |v157|, v56
    v_max3_f32 v56, |v158|, |v159|, v56
    v_mov_b32 v57, 0
    v_cmp_nge_f32_e64 vcc, 2.0, v56
    s_mov_b64 exec, vcc
    ds_write_b32 v57, v55 offset:2312
    s_mov_b64 exec, -1
    v_lshlrev_b32 v31, 2, v45
    v_xor_b32 v31, v31, v14
    v_lshlrev_b32 v31, 4, v31
    s_mov_b32 s69, 2
    s_cmp_eq_u32 s4, 6
    s_cbranch_scc0 P0_NOEXT
    s_waitcnt vmcnt(5)
    v_lshlrev_b32 v118, 16, v19
    v_and_b32 v119, 0xffff0000, v19
    v_lshlrev_b32 v117, 1, v36
    ds_write_b64 v117, v[118:119] offset:0
    v_lshlrev_b32 v112, 16, v20
    v_and_b32 v113, 0xffff0000, v20
    v_mul_f32 v112, s80, v112
    v_mul_f32 v113, s80, v113
    v_cvt_pk_bf16_f32 v114, v112, v113
    v_lshlrev_b32 v115, 16, v114
    v_and_b32 v116, 0xffff0000, v114
    v_sub_f32 v115, v112, v115
    v_sub_f32 v116, v113, v116
    v_cvt_pk_bf16_f32 v115, v115, v116
    v_max_f32_e64 v117, |v112|, |v113|
    ds_max_u32 v57, v117 offset:2316
    v_lshlrev_b32_e64 v116, 16, v21
    ds_write_b32 v36, v114 offset:3392
    ds_write_b32 v36, v115 offset:3712
    ds_write_b32 v36, v116 offset:2816
P0_NOEXT:
    s_add_u32 s48, s44, 1024
    s_addc_u32 s49, s45, 16777216
    v_mov_b32 v16, s72
    v_mov_b32 v17, s73
    v_mul_u32_u24 v254, 2176, v14
    v_lshlrev_b32 v49, 1, v49
    s_movk_i32 s52, 3072
    s_movk_i32 s53, 2048
    s_movk_i32 s54, 1024
    s_movk_i32 s55, 0
    s_movk_i32 s56, 3200
    s_movk_i32 s57, 2176
    s_movk_i32 s58, 1152
    s_movk_i32 s59, 128
    s_mov_b32 s60, 4096
    s_mul_i32 s62, s4, 8704
    s_add_u32 s62, s62, 4096
    s_add_u32 s63, s62, 4096
    s_mov_b32 s64, 48
    s_mov_b32 s65, 0
    s_mov_b32 s71, 0
    s_mov_b32 s70, 0x200000
    v_mul_u32_u24 v56, 528, v14
    v_mul_u32_u24 v57, 328, v14
    v_add_u32 v250, 133888, v56
    v_lshl_or_b32 v247, v57, 16, v56
    v_and_b32 v245, 15, v14
    v_lshlrev_b32 v56, 2, v245
    v_add_u32 v249, 73728, v56
    v_mul_u32_u24 v56, 43, v14
    v_lshrrev_b32 v57, 8, v56
    v_mul_u32_u24 v57, 90, v57
    v_add3_u32 v251, v57, v14, -2
    v_mov_b32 v0, 0
    s_mov_b32 exec_lo, 0x3cf3cf3c
    s_mov_b32 exec_hi, 0xf3cf
    v_mov_b32 v0, 32
    s_mov_b64 exec, -1
    v_add_u32 v56, 86, v56
    v_lshrrev_b32 v56, 8, v56
    v_med3_u32 v56, v56, 2, 7
    s_mov_b32 s5, 0x1181818
    v_mul_lo_u32 v56, v56, s5
    v_add_u32 v248, 0xff7e0, v56
    s_bfm_b64 exec, 10, 0
    v_mov_b32 v248, 0x1280000
    s_bfm_b64 exec, 6, 10
    v_mov_b32 v248, 0x2402800
    s_bfm_b64 exec, 9, 40
    v_mov_b32 v248, 0x7c4a088
    s_bfm_b64 exec, 15, 49
    v_mov_b32 v248, 0x8c4c4a0
    s_mov_b64 exec, -1
    v_lshlrev_b32 v58, 1, v39
    v_lshl_add_u32 v58, v38, 9, v58
    v_add_u32 v1, s62, v58
    v_lshlrev_b32 v2, 4, v48
    v_and_b32 v58, 1, v47
    v_lshlrev_b32 v58, 4, v58
    v_add_u32 v29, 133888, v58
    v_lshl_add_u32 v58, v42, 1, v43
    v_lshlrev_b32_e64 v58, 2, v58
    v_add_u32 v30, 133888, v58
    s_mul_i32 s76, s4, 384
    s_add_u32 s76, s76, 98304
    s_mul_i32 s77, s4, 3072
    v_lshl_add_u32 v240, v37, 2, s76
    v_lshl_add_u32 v241, v40, 2, s76
    v_lshl_add_u32 v242, v44, 2, s76
    v_lshl_add_u32 v58, v38, 6, v249
    v_add_u32 v243, s77, v58
    v_cmp_eq_u32 vcc, 0, v38
    v_mov_b32 v59, 0x03020100
    v_mov_b32 v58, 0x0c080c0c
    v_cndmask_b32 v7, v59, v58, vcc
    v_cndmask_b32 v8, 0, 1, vcc
    v_add_u32 v58, 1, v44
    v_lshrrev_b32 v58, 1, v58
    v_and_b32 v59, 1, v44
    v_mul_u32_u24_e64 v58, v58, v59
    v_mul_u32_u24 v58, 320, v58
    v_add_u32 v58, 3072, v58
    v_mov_b32 v59, 101376
    v_cndmask_b32 v58, v58, v59, vcc
    v_add_u32 v9, v46, v58
    v_cmp_eq_u32 s[6:7], 1, v41
    v_cmp_gt_u32 s[76:77], 2, v40
    v_mov_b32 v58, 0xbf410100
    v_mov_b32 v59, 0xfe800000
    v_cndmask_b32 v58, v58, v59, s[6:7]
    v_cndmask_b32 v59, 0, v58, s[76:77]
    v_cndmask_b32 v58, v58, 0, s[76:77]
    v_cndmask_b32 v24, 1.0, v59, vcc
    v_cndmask_b32 v25, 1.0, v58, vcc
    v_mov_b32 v58, 0xc03fff
    v_mov_b32 v59, 0x3fff0000
    v_cndmask_b32 v58, v58, v59, s[6:7]
    v_cndmask_b32 v59, 0, v58, s[76:77]
    v_cndmask_b32 v58, v58, 0, s[76:77]
    v_cndmask_b32 v252, 0, v59, vcc
    v_cndmask_b32 v253, 0, v58, vcc
    v_lshl_add_u32 v58, v38, 2, v44
    v_lshl_add_u32 v58, v45, 4, v58
    v_lshrrev_b32 v59, 1, v44
    v_lshl_add_u32 v58, v58, 1, v59
    v_and_b32 v59, 31, v46
    v_lshl_add_u32 v58, v58, 6, v59
    v_add_u32 v246, 117504, v58
    s_waitcnt lgkmcnt(0)
    s_barrier
    v_mov_b32_e64 v59, 0
    ds_read_b64 v[22:23], v59 offset:2312
    s_cmp_eq_u32 s4, 1
    s_cbranch_scc0 STWA
    v_lshlrev_b32 v56, 2, v14
    v_mov_b32 v57, 0
    ds_write_b32 v56, v250 offset:2048
    ds_write_b32 v57, v57 offset:2304
    v_lshlrev_b32 v56, 2, v251
    v_add_u32 v56, 98304, v56
    v_lshrrev_b32 v57, 1, v251
    v_lshl_add_u32 v57, v57, 6, v249
    v_and_b32_e64 v58, 1, v251
    v_lshl_add_u32 v57, v58, 1, v57
    v_mov_b32 v58, 0x3f80
    s_mov_b32 exec_lo, 0x3cf3cf3c
    s_mov_b32 exec_hi, 0xf3cf
    ds_write_b32 v56, v247
    ds_write_b16 v57, v58
    s_mov_b64 exec, -1
STWA:
    v_and_b32 v56, 3, v14
    v_lshl_add_u32 v56, v56, 3, v47
    v_lshl_add_u32 v244, v56, 3, s4
    v_mul_u32_u24 v33, 2176, v244
    s_lshr_b32 s5, s3, 2
    s_and_b32 s7, s3, 1
    s_lshl1_add_u32 s5, s5, s7
    s_and_b32 s7, s3, 2
    s_lshl_b32 s7, s7, 6
    s_add_u32 s5, s5, s7
    s_lshl3_add_u32 s5, s5, 3215360
    buffer_load_dwordx2 v[34:35], v33, s[44:47], s5 offen sc1
    s_lshl3_add_u32 s6, s3, 3772416
    s_waitcnt lgkmcnt(0)
    v_or_b32 v16, v16, v22
    v_readfirstlane_b32 s86, v23
    s_waitcnt vmcnt(1)
    s_barrier
    s_cmp_eq_u32 s4, 0
    s_cbranch_scc0 P1_NF
    s_mov_b64 exec, 0xff
    buffer_store_dwordx2 v[16:17], v254, s[44:47], s6 offen sc1
    s_mov_b64 exec, -1
P1_NF:
    s_mul_i32 s6, s3, 12544
    s_mul_i32 s7, s4, 13
    v_add_u32_e64 v56, s7, v14
    v_min_u32 v56, 97, v56
    v_lshl_add_u32 v56, v56, 7, s6
    s_bfm_b64 exec, 13, 0
    buffer_load_dword v57, v56, s[44:47], s60 offen
    s_mov_b64 exec, -1
    s_add_u32 m0, s85, 117504
    s_nop 0
    buffer_load_dwordx4 v31, s[92:95], s85 offen offset:0 lds
    buffer_load_dwordx4 v31, s[92:95], s85 offen offset:1024 lds
    ds_read_b128 v[144:147], v49 offset:0
    ds_read_b128 v[148:151], v49 offset:32
    ds_read_b128 v[152:155], v49 offset:64
    ds_read_b128 v[156:159], v49 offset:96
    ds_read_b64_tr_b16 v[80:81], v50 offset:47616
    ds_read_b64_tr_b16 v[82:83], v50 offset:48640
    ds_read_b64_tr_b16 v[84:85], v50 offset:51712
    ds_read_b64_tr_b16 v[86:87], v50 offset:52736
    ds_read_b64_tr_b16 v[88:89], v50 offset:55808
    ds_read_b64_tr_b16 v[90:91], v50 offset:56832
    ds_read_b64_tr_b16 v[92:93], v50 offset:59904
    ds_read_b64_tr_b16 v[94:95], v50 offset:60928
    s_waitcnt lgkmcnt(6)
    v_mfma_f32_32x32x16_bf16 v[144:159], v[80:83], v[160:163], v[144:159]
    s_waitcnt lgkmcnt(4)
    v_mfma_f32_32x32x16_bf16 v[144:159], v[84:87], v[164:167], v[144:159]
    s_waitcnt lgkmcnt(2)
    v_mfma_f32_32x32x16_bf16 v[144:159], v[88:91], v[168:171], v[144:159]
    s_waitcnt lgkmcnt(0)
    v_mfma_f32_32x32x16_bf16 v[144:159], v[92:95], v[172:175], v[144:159]
    s_mov_b32 s80, 0xbf39639f
    s_mov_b32 s81, s80
    s_nop 7
    s_nop 1
    v_pk_mul_f32 v[144:145], v[144:145], s[80:81]
    s_nop 0
    v_pk_mul_f32 v[146:147], v[146:147], s[80:81]
    v_pk_mul_f32 v[148:149], v[148:149], s[80:81]
    v_pk_mul_f32 v[150:151], v[150:151], s[80:81]
    v_pk_mul_f32 v[152:153], v[152:153], s[80:81]
    v_pk_mul_f32 v[154:155], v[154:155], s[80:81]
    v_pk_mul_f32 v[156:157], v[156:157], s[80:81]
    v_pk_mul_f32 v[158:159], v[158:159], s[80:81]
    v_cvt_pk_bf16_f32 v64, v144, v145
    v_cvt_pk_bf16_f32 v65, v146, v147
    v_cvt_pk_bf16_f32 v66, v148, v149
    v_cvt_pk_bf16_f32 v67, v150, v151
    v_cvt_pk_bf16_f32 v68, v152, v153
    v_cvt_pk_bf16_f32 v69, v154, v155
    v_cvt_pk_bf16_f32 v70, v156, v157
    v_cvt_pk_bf16_f32 v71, v158, v159
    v_max_f32_e64 v58, |v144|, |v145|
    v_max3_f32 v58, |v146|, |v147|, v58
    v_max3_f32 v58, |v148|, |v149|, v58
    v_max3_f32 v58, |v150|, |v151|, v58
    v_max3_f32 v58, |v152|, |v153|, v58
    v_max3_f32 v58, |v154|, |v155|, v58
    v_max3_f32 v58, |v156|, |v157|, v58
    v_max3_f32 v58, |v158|, |v159|, v58
    v_cmp_nge_f32 s[90:91], 1.0, v58
    s_mov_b64 exec, s[88:89]
    ds_write_b64 v54, v[64:65] offset:0
    ds_write_b64 v54, v[66:67] offset:16
    ds_write_b64 v54, v[68:69] offset:32
    ds_write_b64 v54, v[70:71] offset:48
    s_mov_b64 exec, -1
POLL1:
    v_mul_u32_u24 v32, 20352, v244
    v_and_b32 v37, 7, v14
    v_lshlrev_b32 v37, 1, v37
    v_add_u32 v36, s65, v37
    v_mul_u32_u24 v36, 6, v36
    v_add_u32 v38, 1, v37
    v_add_u32 v39, 16, v37
    v_add_u32 v40, 17, v37
    s_mov_b32 s7, 3807232
    v_mov_b32 v55, 4
    s_waitcnt vmcnt(3)
POLL:
    v_xor_b32 v34, s72, v34
    v_cmp_ne_u32 s[76:77], s73, v35
    v_cmp_le_u32 vcc, 0x1000000, v34
    s_or_b64 vcc, vcc, s[76:77]
    s_cbranch_scc0 POLLED
    s_sub_u32 s70, s70, 1
    s_cbranch_scc1 K_END
    buffer_load_dwordx2 v[34:35], v33, s[44:47], s5 offen sc1
    s_waitcnt vmcnt(0)
    s_branch POLL
POLLED:
    v_and_b32 v35, 0xfff, v34
    v_lshrrev_b32 v34, 12, v34
    v_mad_u32_u24 v35, v35, 6, v32
    v_subrev_u32 v34, s65, v34
    v_cmp_lt_i32 s[74:75], s64, v34
    v_min_i32 v34, s64, v34
    v_cmp_lt_i32 s[80:81], 32, v34
    s_nop 0
    v_mov_b32_dpp v43, v34 quad_perm:[0,0,0,0] row_mask:0xf bank_mask:0xf
    v_add_u32_dpp v44, v35, v36 quad_perm:[0,0,0,0] row_mask:0xf bank_mask:0xf
    v_cmp_lt_i32 s[8:9], v37, v43
    v_cmp_lt_i32 s[10:11], v38, v43
    v_cmp_lt_i32 s[24:25], v39, v43
    v_cmp_lt_i32 s[26:27], v40, v43
    v_mov_b32_dpp v43, v34 quad_perm:[1,1,1,1] row_mask:0xf bank_mask:0xf
    v_add_u32_dpp v45, v35, v36 quad_perm:[1,1,1,1] row_mask:0xf bank_mask:0xf
    v_cmp_lt_i32 s[12:13], v37, v43
    v_cmp_lt_i32 s[14:15], v38, v43
    v_cmp_lt_i32 s[28:29], v39, v43
    v_cmp_lt_i32 s[30:31], v40, v43
    v_mov_b32_dpp v43, v34 quad_perm:[2,2,2,2] row_mask:0xf bank_mask:0xf
    v_add_u32_dpp v46, v35, v36 quad_perm:[2,2,2,2] row_mask:0xf bank_mask:0xf
    v_cmp_lt_i32 s[16:17], v37, v43
    v_cmp_lt_i32 s[18:19], v38, v43
    v_cmp_lt_i32 s[32:33], v39, v43
    v_cmp_lt_i32 s[34:35], v40, v43
    v_mov_b32_dpp v43, v34 quad_perm:[3,3,3,3] row_mask:0xf bank_mask:0xf
    v_add_u32_dpp v47, v35, v36 quad_perm:[3,3,3,3] row_mask:0xf bank_mask:0xf
    v_cmp_lt_i32 s[20:21], v37, v43
    v_cmp_lt_i32 s[22:23], v38, v43
    v_cmp_lt_i32 s[36:37], v39, v43
    v_cmp_lt_i32 s[38:39], v40, v43
    v_lshlrev_b32 v54, 2, v14
    v_mov_b32 v53, 0
    s_mov_b64 exec, s[74:75]
    ds_write_b32 v53, v55 offset:2304
    s_mov_b64 exec, -1
    v_mov_b32 v15, v240
    v_mov_b32 v28, v241
    v_mov_b32 v5, v242
    v_mov_b32 v6, v243
    ds_read_u16 v3, v15
    ds_read_u16 v4, v28
    ds_read_u16 v10, v5 offset:2
    v_mov_b32 v16, 0
    v_mov_b32 v18, 1.0
    v_mov_b32 v17, 0
    v_mov_b32 v19, 1.0
    v_mov_b32_e64 v12, 0
    v_mov_b32_e64 v65, v2
    v_mov_b32_e64 v67, v2
    v_mov_b32_e64 v69, v2
    v_mov_b32_e64 v71, v2
    v_pk_mul_f32 v[76:77], v[16:17], v[16:17]
    v_pk_mul_f32 v[78:79], v[16:17], v[16:17]
    v_pk_mul_f32 v[80:81], v[16:17], v[16:17]
    v_pk_mul_f32 v[82:83], v[16:17], v[16:17]
    v_pk_mul_f32 v[84:85], v[16:17], v[16:17]
    v_pk_mul_f32 v[86:87], v[16:17], v[16:17]
    v_pk_mul_f32 v[88:89], v[16:17], v[16:17]
    v_pk_mul_f32 v[90:91], v[16:17], v[16:17]
    v_pk_mul_f32 v[92:93], v[16:17], v[16:17]
    v_pk_mul_f32 v[94:95], v[16:17], v[16:17]
    v_pk_mul_f32 v[144:145], v[16:17], v[16:17]
    v_pk_mul_f32 v[146:147], v[16:17], v[16:17]
    v_pk_mul_f32 v[148:149], v[16:17], v[16:17]
    v_pk_mul_f32 v[150:151], v[16:17], v[16:17]
    v_pk_mul_f32 v[152:153], v[16:17], v[16:17]
    v_pk_mul_f32 v[154:155], v[16:17], v[16:17]
    v_pk_mul_f32 v[156:157], v[16:17], v[16:17]
    v_pk_mul_f32 v[158:159], v[16:17], v[16:17]
    v_pk_mul_f32 v[160:161], v[16:17], v[16:17]
    v_pk_mul_f32 v[162:163], v[16:17], v[16:17]
    v_pk_mul_f32 v[164:165], v[16:17], v[16:17]
    v_pk_mul_f32 v[166:167], v[16:17], v[16:17]
    v_pk_mul_f32 v[168:169], v[16:17], v[16:17]
    v_pk_mul_f32 v[170:171], v[16:17], v[16:17]
    v_pk_mul_f32 v[172:173], v[16:17], v[16:17]
    v_pk_mul_f32 v[174:175], v[16:17], v[16:17]
    s_waitcnt lgkmcnt(0)
    v_add_u32 v3, v3, v29
    v_add_u32 v4, v4, v30
    v_mad_u32_u24 v11, v10, v8, v9
    v_and_b32_e64 v62, -8, v244
    s_and_b32 s84, s2, 7
    s_mul_i32 s84, s84, 2176
    s_lshl_b32 s83, s4, 8
    s_add_u32 s84, s84, s83
    s_add_u32 s84, s84, 3772416
    buffer_load_dwordx2 v[60:61], v62, s[44:47], s84 offen sc1
FPOLL:
    s_waitcnt vmcnt(0)
    v_cmp_ne_u32 s[76:77], s73, v61
    v_xor_b32 v60, s72, v60
    v_cmp_lt_u32_e64 vcc, 1, v60
    s_or_b64 vcc, vcc, s[76:77]
    s_cbranch_scc0 FPOLLED
    s_sub_u32 s70, s70, 1
    s_cbranch_scc1 K_END
    buffer_load_dwordx2 v[60:61], v62, s[44:47], s84 offen sc1
    s_branch FPOLL
FPOLLED:
    s_cmp_lg_u64 s[80:81], 0
    s_cbranch_scc1 R_THIRD
R_THIRDB:
    s_mov_b64 exec, s[24:25]
    s_cbranch_execz R_L4
    buffer_load_dwordx3 v[128:130], v44, s[44:47], s7 offen offset:96 sc1
R_L4:
    s_mov_b64 exec, s[28:29]
    s_cbranch_execz R_L5
    buffer_load_dwordx3 v[132:134], v45, s[44:47], s7 offen offset:96 sc1
R_L5:
    s_mov_b64 exec, s[32:33]
    s_cbranch_execz R_L6
    buffer_load_dwordx3 v[136:138], v46, s[44:47], s7 offen offset:96 sc1
R_L6:
    s_mov_b64 exec, s[36:37]
    s_cbranch_execz R_L7
    buffer_load_dwordx3 v[140:142], v47, s[44:47], s7 offen offset:96 sc1
R_L7:
    s_or_b64 exec, s[8:9], 1
    buffer_load_dwordx3 v[112:114], v44, s[44:47], s7 offen sc1
    s_or_b64 exec, s[12:13], 1
    buffer_load_dwordx3 v[116:118], v45, s[44:47], s7 offen sc1
    s_or_b64 exec, s[16:17], 1
    buffer_load_dwordx3 v[120:122], v46, s[44:47], s7 offen sc1
    s_or_b64 exec, s[20:21], 1
    buffer_load_dwordx3 v[124:126], v47, s[44:47], s7 offen sc1
    s_mov_b64 exec, -1
    s_cmp_eq_u32 s69, 2
    s_cbranch_scc0 R_NH
    v_pk_mul_f32 v[176:177], v[16:17], v[16:17]
    v_pk_mul_f32 v[178:179], v[16:17], v[16:17]
    v_pk_mul_f32 v[180:181], v[16:17], v[16:17]
    v_pk_mul_f32 v[182:183], v[16:17], v[16:17]
    v_pk_mul_f32 v[184:185], v[16:17], v[16:17]
    v_pk_mul_f32 v[186:187], v[16:17], v[16:17]
    v_pk_mul_f32 v[188:189], v[16:17], v[16:17]
    v_pk_mul_f32 v[190:191], v[16:17], v[16:17]
    v_pk_mul_f32 v[192:193], v[16:17], v[16:17]
    v_pk_mul_f32 v[194:195], v[16:17], v[16:17]
    v_pk_mul_f32 v[196:197], v[16:17], v[16:17]
    v_pk_mul_f32 v[198:199], v[16:17], v[16:17]
    v_pk_mul_f32 v[200:201], v[16:17], v[16:17]
    v_pk_mul_f32 v[202:203], v[16:17], v[16:17]
    v_pk_mul_f32 v[204:205], v[16:17], v[16:17]
    v_pk_mul_f32 v[206:207], v[16:17], v[16:17]
    v_pk_mul_f32 v[208:209], v[16:17], v[16:17]
    v_pk_mul_f32 v[210:211], v[16:17], v[16:17]
    v_pk_mul_f32 v[212:213], v[16:17], v[16:17]
    v_pk_mul_f32 v[214:215], v[16:17], v[16:17]
    v_pk_mul_f32 v[216:217], v[16:17], v[16:17]
    v_pk_mul_f32 v[218:219], v[16:17], v[16:17]
    v_pk_mul_f32 v[220:221], v[16:17], v[16:17]
    v_pk_mul_f32 v[222:223], v[16:17], v[16:17]
    v_pk_mul_f32 v[224:225], v[16:17], v[16:17]
    v_pk_mul_f32 v[226:227], v[16:17], v[16:17]
    v_pk_mul_f32 v[228:229], v[16:17], v[16:17]
    v_pk_mul_f32 v[230:231], v[16:17], v[16:17]
    v_pk_mul_f32 v[232:233], v[16:17], v[16:17]
    v_pk_mul_f32 v[234:235], v[16:17], v[16:17]
    v_pk_mul_f32 v[236:237], v[16:17], v[16:17]
    v_pk_mul_f32 v[238:239], v[16:17], v[16:17]
R_NH:
    s_mov_b32 s69, 0
    s_lshr_b32 s6, s2, 3
    s_lshl_b32 s7, s4, 5
    s_add_u32 s6, s6, s7
    s_mul_i32 s6, s6, 12544
    v_lshl_add_u32 v56, v14, 7, s6
    v_lshrrev_b32 v41, 8, v248
    v_lshrrev_b32 v42, 16, v248
    v_lshrrev_b32 v43, 24, v248
    v_add_u32 v44, -1, v43
    v_mul_u32_u24 v48, 96, v44
    v_add_u32 v48, 4, v48
    v_add_u32 v49, 96, v48
    v_mov_b32 v39, v247
    s_mul_i32 s6, s4, -360
    s_add_u32 s6, s6, 4294869000
    v_add_u32 v58, s6, v15
    v_add_u32 v59, s6, v28
    s_mov_b32 s6, 133892
    s_movk_i32 s7, 132
    v_mov_b32 v61, s6
    v_mad_u32_u24 v62, v58, s7, v61
    v_mad_u32_u24 v63, v59, s7, v61
    v_sub_u32 v50, 28, v250
    v_sub_u32 v50, v50, v0
    v_mov_b32 v51, 0xff
    s_mul_i32 s83, s4, 6
    s_add_u32 s83, s83, 7
    v_cmp_ne_u32 s[76:77], 0, v60
    s_or_b64 s[74:75], s[76:77], s[90:91]
    s_waitcnt vmcnt(4)
    s_mov_b64 exec, s[24:25]
    v_lshrrev_b32 v131, 16, v129
    v_and_b32_e64 v129, v51, v129
    ds_add_rtn_u32 v104, v129, v55 offset:2048
    v_max_f32_e64 v12, |v128|, v12
    s_mov_b64 exec, s[26:27]
    ds_add_rtn_u32 v105, v131, v55 offset:2048
    v_max_f32_e64 v12, |v130|, v12
R_A9:
    s_mov_b64 exec, s[28:29]
    v_lshrrev_b32_e64 v135, 16, v133
    v_and_b32 v133, v51, v133
    ds_add_rtn_u32 v106, v133, v55 offset:2048
    v_max_f32_e64 v12, |v132|, v12
    s_mov_b64 exec, s[30:31]
    ds_add_rtn_u32 v107, v135, v55 offset:2048
    v_max_f32_e64 v12, |v134|, v12
R_A11:
    s_mov_b64 exec, s[32:33]
    v_lshrrev_b32 v139, 16, v137
    v_and_b32_e64 v137, v51, v137
    ds_add_rtn_u32 v108, v137, v55 offset:2048
    v_max_f32_e64 v12, |v136|, v12
    s_mov_b64 exec, s[34:35]
    ds_add_rtn_u32 v109, v139, v55 offset:2048
    v_max_f32_e64 v12, |v138|, v12
R_A13:
    s_mov_b64 exec, s[36:37]
    v_lshrrev_b32 v143, 16, v141
    v_and_b32_e64 v141, v51, v141
    ds_add_rtn_u32 v110, v141, v55 offset:2048
    v_max_f32_e64 v12, |v140|, v12
    s_mov_b64 exec, s[38:39]
    ds_add_rtn_u32 v111, v143, v55 offset:2048
    v_max_f32_e64 v12, |v142|, v12
R_A15:
    s_mov_b64 exec, s[8:9]
    s_waitcnt vmcnt(3)
    v_lshrrev_b32_e64 v115, 16, v113
    v_and_b32 v113, v51, v113
    ds_add_rtn_u32 v96, v113, v55 offset:2048
    v_max_f32_e64 v12, |v112|, v12
    s_mov_b64 exec, s[10:11]
    ds_add_rtn_u32 v97, v115, v55 offset:2048
    v_max_f32_e64 v12, |v114|, v12
    s_mov_b64 exec, s[12:13]
    s_waitcnt vmcnt(2)
    v_lshrrev_b32 v119, 16, v117
    v_and_b32 v117, v51, v117
    ds_add_rtn_u32 v98, v117, v55 offset:2048
    v_max_f32_e64 v12, |v116|, v12
    s_mov_b64 exec, s[14:15]
    ds_add_rtn_u32 v99, v119, v55 offset:2048
    v_max_f32_e64 v12, |v118|, v12
    s_mov_b64 exec, s[16:17]
    s_waitcnt vmcnt(1)
    v_lshrrev_b32 v123, 16, v121
    v_and_b32 v121, v51, v121
    ds_add_rtn_u32 v100, v121, v55 offset:2048
    v_max_f32_e64 v12, |v120|, v12
    s_mov_b64 exec, s[18:19]
    ds_add_rtn_u32 v101, v123, v55 offset:2048
    v_max_f32_e64 v12, |v122|, v12
    s_mov_b64 exec, s[20:21]
    s_waitcnt vmcnt(0)
    v_lshrrev_b32 v127, 16, v125
    v_and_b32 v125, v51, v125
    ds_add_rtn_u32 v102, v125, v55 offset:2048
    v_max_f32_e64 v12, |v124|, v12
    s_mov_b64 exec, s[22:23]
    ds_add_rtn_u32 v103, v127, v55 offset:2048
    v_max_f32_e64 v12, |v126|, v12
    s_bfm_b64 exec, 12, 0
    buffer_load_dword v57, v56, s[44:47], s60 offen
    s_mov_b64 exec, -1
    v_mul_f32 v12, s86, v12
    v_cmp_nge_f32 vcc, 0x412e6666, v12
    s_or_b64 exec, s[74:75], vcc
    ds_write_b32 v53, v55 offset:2308
    s_waitcnt lgkmcnt(0)
    s_mov_b64 exec, s[24:25]
    ds_write_b32 v104, v128
    s_mov_b64 exec, s[26:27]
    ds_write_b32 v105, v130
R_C9:
    s_mov_b64 exec, s[28:29]
    ds_write_b32 v106, v132
    s_mov_b64 exec, s[30:31]
    ds_write_b32 v107, v134
R_C11:
    s_mov_b64 exec, s[32:33]
    ds_write_b32 v108, v136
    s_mov_b64 exec, s[34:35]
    ds_write_b32 v109, v138
R_C13:
    s_mov_b64 exec, s[36:37]
    ds_write_b32 v110, v140
    s_mov_b64 exec, s[38:39]
    ds_write_b32 v111, v142
R_C15:
    s_mov_b64 exec, s[8:9]
    ds_write_b32 v96, v112
    s_mov_b64 exec, s[10:11]
    ds_write_b32 v97, v114
    s_mov_b64 exec, s[12:13]
    ds_write_b32 v98, v116
    s_mov_b64 exec, s[14:15]
    ds_write_b32 v99, v118
    s_mov_b64 exec, s[16:17]
    ds_write_b32 v100, v120
    s_mov_b64 exec, s[18:19]
    ds_write_b32 v101, v122
    s_mov_b64 exec, s[20:21]
    ds_write_b32 v102, v124
    s_mov_b64 exec, s[22:23]
    ds_write_b32 v103, v126
    s_mov_b64 exec, -1
    s_mov_b32 m0, s62
    s_waitcnt lgkmcnt(0)
    s_barrier
    ds_read_b32 v58, v58 offset:2048
    ds_read_b32 v59, v59 offset:2048
    ds_read_b32 v32, v54 offset:2048
    ds_read_b64 v[46:47], v53 offset:2304
    ds_read_b32 v34, v54 offset:2368
    s_mov_b32 s82, 98304
    s_mov_b32 s69, 1
    v_mov_b32 v52, 0x3f80
    s_movk_i32 s5, 128
    s_waitcnt lgkmcnt(4)
    v_sub_u32_e64 v58, v58, v62 clamp
    v_and_b32 v58, 0x1e0, v58
    v_add_u32 v3, v3, v58
    ds_read_u16 v64, v3 offset:0
    ds_read_u16 v66, v3 offset:4
    ds_read_u16 v68, v3 offset:8
    ds_read_u16 v70, v3 offset:12
    s_waitcnt lgkmcnt(6)
    v_add_u32 v35, v32, v50
    v_max_i32 v35, 0, v35
    v_lshrrev_b32 v35, 5, v35
    v_sub_u32_e64 v59, v59, v63 clamp
    v_and_b32 v59, 0x1e0, v59
    v_add_u32_dpp v36, v35, v35 row_shr:1 row_mask:0xf bank_mask:0xf bound_ctrl:1
    v_add_u32_e64 v4, v4, v59
    ds_read_b32 v26, v4
    v_add_u32_dpp v36, v36, v36 row_shr:2 row_mask:0xf bank_mask:0xf bound_ctrl:1
    v_sub_u32_e64 v32, v32, v250
    v_lshrrev_b32 v32, 2, v32
    v_add_u32_dpp v36, v36, v36 row_shr:4 row_mask:0xf bank_mask:0xf bound_ctrl:1
    s_waitcnt lgkmcnt(1)
    buffer_load_dwordx4 v[64:65], s[48:51], s52 idxen offen offset:0 sc1 lds
    v_add_u32_dpp v36, v36, v36 row_shr:8 row_mask:0xf bank_mask:0xf bound_ctrl:1
    buffer_load_dwordx4 v[66:67], s[48:51], s53 idxen offen offset:1024 sc1 lds
    buffer_load_dwordx4 v[68:69], s[48:51], s54 idxen offen offset:2048 sc1 lds
    v_add_u32_dpp v36, v36, v36 row_bcast:15 row_mask:0xa bank_mask:0xf
    buffer_load_dwordx4 v[70:71], s[48:51], s55 idxen offen offset:3072 sc1 lds
    v_cmp_lt_u32 s[76:77], s5, v32
    v_add_u32_dpp v36, v36, v36 row_bcast:31 row_mask:0xc bank_mask:0xf
    v_readfirstlane_b32 s67, v47
    v_readlane_b32 s7, v36, 63
    v_sub_u32 v36, v36, v35
    ds_bpermute_b32 v40, v248, v36
    ds_bpermute_b32 v41, v41, v36
    ds_bpermute_b32 v42, v42, v36
    v_readfirstlane_b32 s66, v46
    v_add_u32 v34, v34, v32
    s_add_u32 s7, s7, 3
    s_bfe_u32 s6, s7, 0x30002
    s_lshr_b32 s7, s7, 5
    v_min_u32 v37, s6, v44
    v_min_u32 v38, s6, v43
    v_mad_u32_u24 v37, v44, s7, v37
    v_mad_u32_u24 v38, v43, s7, v38
    v_lshlrev_b32 v37, 2, v37
    v_lshlrev_b32_e64 v38, 2, v38
    s_waitcnt lgkmcnt(0)
    v_med3_u32 v37, v37, v40, v41
    v_med3_u32 v38, v38, v41, v42
    v_sub_u32 v45, v38, v37
    v_cmp_lt_u32 vcc, 84, v45
    v_sub_u32 v37, v48, v37
    v_readlane_b32 s68, v45, s83
    v_sub_u32 v33, v49, v38
    s_cbranch_vccnz R_SHRINK
R_FITS:
    s_cmp_eq_u64 s[76:77], 0
    s_cbranch_scc0 R_COMPACT
R_TABLE:
    s_mov_b32 s6, s4
    v_cmp_lt_u32 vcc, s6, v35
    s_and_b64 exec, exec, vcc
R_GT:
    v_add_u32 v44, s6, v36
    v_cmp_lt_u32 vcc, v44, v38
    s_lshl_b32 s7, s6, 5
    v_add_u32 v47, s7, v39
    v_cndmask_b32 v45, v33, v37, vcc
    s_add_u32 s6, s6, 8
    v_add_u32 v44, v44, v45
    v_cmp_lt_u32_e64 vcc, s6, v35
    v_lshl_add_u32 v45, v44, 2, s82
    ds_write_b32 v45, v47
    v_lshrrev_b32_e64 v46, 1, v44
    v_lshl_add_u32 v46, v46, 6, v249
    v_and_b32_e64 v44, 1, v44
    v_lshl_add_u32 v46, v44, 1, v46
    ds_write_b16 v46, v52
    s_and_b64 exec, exec, vcc
    s_cbranch_execnz R_GT
R_GTE:
    s_mov_b64 exec, -1
    s_add_u32 s68, s68, 7
    s_lshr_b32 s68, s68, 2
    s_cmp_eq_u32 s4, 7
    s_cselect_b64 exec, -1, 0
    ds_write_b32 v54, v34 offset:2368
    s_mov_b64 exec, -1
    s_mov_b64 exec, 1
    ds_add_u32 v53, v55 offset:2320
    s_mov_b64 exec, -1
    s_add_u32 s71, s71, 32
    s_cmp_eq_u32 s69, 0
    s_cbranch_scc1 R_LATE
WAVE_GO:
    s_mov_b32 m0, s63
    v_perm_b32 v26, v26, v26, v7
    v_xor_b32_e64 v27, 64, v246
    v_pk_fma_f32 v[22:23], v[24:25], v[26:27], v[252:253] op_sel_hi:[1,0,1]
    buffer_load_dwordx4 v[64:65], s[48:51], s56 idxen offen offset:0 sc1 lds
    buffer_load_dwordx4 v[66:67], s[48:51], s57 idxen offen offset:1024 sc1 lds
    buffer_load_dwordx4 v[68:69], s[48:51], s58 idxen offen offset:2048 sc1 lds
    s_nop 0
    buffer_load_dwordx4 v[70:71], s[48:51], s59 idxen offen offset:3072 sc1 lds
    s_waitcnt vmcnt(4)
    ds_read_u16_d16_hi v144, v1 offset:0
    ds_read_u16_d16_hi v145, v1 offset:256
    ds_read_u16_d16_hi v146, v1 offset:1024
    ds_read_u16_d16_hi v147, v1 offset:1280
    ds_read_u16_d16_hi v148, v1 offset:2048
    ds_read_u16_d16_hi v149, v1 offset:2304
    ds_read_u16_d16_hi v150, v1 offset:3072
    ds_read_u16_d16_hi v151, v1 offset:3328
    ds_read_u16_d16_hi v152, v1 offset:128
    ds_read_u16_d16_hi v153, v1 offset:384
    ds_read_u16_d16_hi v154, v1 offset:1152
    ds_read_u16_d16_hi v155, v1 offset:1408
    ds_read_u16_d16_hi v156, v1 offset:2176
    ds_read_u16_d16_hi v157, v1 offset:2432
    ds_read_u16_d16_hi v158, v1 offset:3200
    ds_read_u16_d16_hi v159, v1 offset:3456
    ds_read_b64_tr_b16 v[72:73], v11 offset:0
    ds_read_u16_d16_hi v160, v1 offset:64
    ds_read_u16_d16_hi v161, v1 offset:320
    ds_read_u16_d16_hi v162, v1 offset:1088
    ds_read_u16_d16_hi v163, v1 offset:1344
    ds_read_u16_d16_hi v164, v1 offset:2112
    ds_read_u16_d16_hi v165, v1 offset:2368
    ds_read_u16_d16_hi v166, v1 offset:3136
    ds_read_u16_d16_hi v167, v1 offset:3392
    ds_read_u16_d16_hi v168, v1 offset:192
    ds_read_u16_d16_hi v169, v1 offset:448
    ds_read_u16_d16_hi v170, v1 offset:1216
    s_waitcnt lgkmcnt(11)
    v_mfma_f32_32x32x8_bf16 v[112:127], v[22:23], v[72:73], v[144:159]
    ds_read_u16_d16_hi v171, v1 offset:1472
    ds_read_u16_d16_hi v172, v1 offset:2240
    ds_read_u16_d16_hi v173, v1 offset:2496
    ds_read_u16_d16_hi v174, v1 offset:3264
    ds_read_u16_d16_hi v175, v1 offset:3520
    ds_read_b64_tr_b16 v[74:75], v11 offset:64
    s_sub_u32 s61, s68, 1
    s_mov_b32 m0, s62
    ds_read_b32 v31, v53 offset:2320
    ds_read_u16 v3, v15 offset:16
    ds_read_u16 v4, v28 offset:16
    s_cmp_lg_u32 s67, 0
    s_waitcnt lgkmcnt(3)
    s_cbranch_scc1 PEELS
.p2align 3
PEELF:
    v_exp_f32 v96, v112
    s_setprio 3
    v_mfma_f32_32x32x8_bf16 v[128:143], v[22:23], v[74:75], v[160:175]
    v_exp_f32 v97, v113
    v_rcp_f32 v20, v18
    v_rcp_f32 v21, v19
    v_exp_f32 v98, v114
    v_exp_f32 v99, v115
    v_exp_f32 v100, v116
    v_exp_f32_e64 v101, v117
    v_pk_mul_f32 v[20:21], v[16:17], v[20:21]
    v_pk_add_f32 v[18:19], v[96:97], 1.0 op_sel_hi:[1,0]
    v_cvt_pk_bf16_f32 v95, v20, v21
    v_pk_fma_f32 v[16:17], v[112:113], v[98:99], v[112:113]
    v_pk_fma_f32 v[16:17], v[114:115], v[18:19], v[16:17]
    v_pk_fma_f32 v[18:19], v[18:19], v[98:99], v[18:19]
    v_exp_f32 v102, v118
    v_exp_f32 v103, v119
    v_pk_fma_f32 v[16:17], v[16:17], v[100:101], v[16:17]
    v_pk_fma_f32 v[16:17], v[116:117], v[18:19], v[16:17]
    v_pk_fma_f32 v[18:19], v[18:19], v[100:101], v[18:19]
    v_exp_f32 v104, v120
    v_exp_f32 v105, v121
    v_pk_fma_f32 v[16:17], v[16:17], v[102:103], v[16:17]
    v_pk_fma_f32 v[16:17], v[118:119], v[18:19], v[16:17]
    v_pk_fma_f32 v[18:19], v[18:19], v[102:103], v[18:19]
    v_exp_f32 v106, v122
    v_exp_f32 v107, v123
    v_pk_fma_f32 v[16:17], v[16:17], v[104:105], v[16:17]
    v_pk_fma_f32 v[16:17], v[120:121], v[18:19], v[16:17]
    v_pk_fma_f32 v[18:19], v[18:19], v[104:105], v[18:19]
    v_exp_f32 v108, v124
    v_exp_f32 v109, v125
    v_pk_fma_f32 v[16:17], v[16:17], v[106:107], v[16:17]
    v_pk_fma_f32 v[16:17], v[122:123], v[18:19], v[16:17]
    v_pk_fma_f32 v[18:19], v[18:19], v[106:107], v[18:19]
    v_exp_f32 v110, v126
    v_exp_f32 v111, v127
    v_pk_fma_f32 v[16:17], v[16:17], v[108:109], v[16:17]
    v_pk_fma_f32 v[16:17], v[124:125], v[18:19], v[16:17]
    v_pk_fma_f32 v[18:19], v[18:19], v[108:109], v[18:19]
    v_pk_fma_f32 v[16:17], v[16:17], v[110:111], v[16:17]
    v_pk_fma_f32 v[16:17], v[126:127], v[18:19], v[16:17]
    v_pk_fma_f32 v[18:19], v[18:19], v[110:111], v[18:19]
TCHKF:
    s_waitcnt lgkmcnt(0)
    v_readfirstlane_b32 s5, v31
    v_add_u32 v3, v3, v29
    v_add_u32 v4, v4, v30
    s_cmp_lt_u32 s5, s71
    s_cbranch_scc1 TWAITF
    ds_read_u16 v64, v3 offset:0
    ds_read_u16 v66, v3 offset:4
    ds_read_u16 v68, v3 offset:8
    ds_read_u16 v70, v3 offset:12
    s_setprio 0
    s_waitcnt lgkmcnt(0)
    buffer_load_dwordx4 v[64:65], s[48:51], s52 idxen offen offset:0 sc1 lds
    buffer_load_dwordx4 v[66:67], s[48:51], s53 idxen offen offset:1024 sc1 lds
    buffer_load_dwordx4 v[68:69], s[48:51], s54 idxen offen offset:2048 sc1 lds
    buffer_load_dwordx4 v[70:71], s[48:51], s55 idxen offen offset:3072 sc1 lds
LOOPF:
SLOTF0:
    s_setprio 0
    s_waitcnt vmcnt(4)
    ds_read_u16_d16_hi v144, v1 offset:4096
    ds_read_u16_d16_hi v145, v1 offset:4352
    ds_read_u16_d16_hi v146, v1 offset:5120
    ds_read_u16_d16_hi v147, v1 offset:5376
    ds_read_u16_d16_hi v148, v1 offset:6144
    ds_read_u16_d16_hi v149, v1 offset:6400
    ds_read_u16_d16_hi v150, v1 offset:7168
    ds_read_u16_d16_hi v151, v1 offset:7424
    ds_read_u16_d16_hi v152, v1 offset:4224
    ds_read_u16_d16_hi v153, v1 offset:4480
    ds_read_u16_d16_hi v154, v1 offset:5248
    ds_read_u16_d16_hi v155, v1 offset:5504
    ds_read_u16_d16_hi v156, v1 offset:6272
    ds_read_u16_d16_hi v157, v1 offset:6528
    ds_read_u16_d16_hi v158, v1 offset:7296
    ds_read_u16_d16_hi v159, v1 offset:7552
    ds_read_u16_d16_hi v160, v1 offset:4160
    ds_read_u16_d16_hi v161, v1 offset:4416
    ds_read_u16_d16_hi v162, v1 offset:5184
    ds_read_u16_d16_hi v163, v1 offset:5440
    ds_read_u16_d16_hi v164, v1 offset:6208
    ds_read_u16_d16_hi v165, v1 offset:6464
    ds_read_u16_d16_hi v166, v1 offset:7232
    ds_read_u16_d16_hi v167, v1 offset:7488
    ds_read_u16_d16_hi v168, v1 offset:4288
    ds_read_u16_d16_hi v169, v1 offset:4544
    ds_read_u16_d16_hi v170, v1 offset:5312
    ds_read_u16_d16_hi v171, v1 offset:5568
    ds_read_u16_d16_hi v172, v1 offset:6336
    ds_read_u16_d16_hi v173, v1 offset:6592
    ds_read_u16_d16_hi v174, v1 offset:7360
    ds_read_u16_d16_hi v175, v1 offset:7616
    ds_read_b64_tr_b16 v[72:73], v11 offset:128
    ds_read_b64_tr_b16 v[74:75], v11 offset:192
    ds_read_u16 v3, v15 offset:32
    ds_read_b32 v26, v4
    ds_read_u16 v10, v5 offset:18
    s_mov_b32 m0, s63
    s_cmp_eq_u32 s61, 0
    s_waitcnt lgkmcnt(0)
    s_cbranch_scc1 SKDF0
    buffer_load_dwordx4 v[64:65], s[48:51], s56 idxen offen offset:0 sc1 lds
    buffer_load_dwordx4 v[66:67], s[48:51], s57 idxen offen offset:1024 sc1 lds
    buffer_load_dwordx4 v[68:69], s[48:51], s58 idxen offen offset:2048 sc1 lds
    buffer_load_dwordx4 v[70:71], s[48:51], s59 idxen offen offset:3072 sc1 lds
SKDF0:
    v_exp_f32 v96, v128
    v_exp_f32 v97, v129
    v_mfma_f32_32x32x16_bf16 v[192:207], v[84:87], v[76:79], v[192:207]
    s_setprio 3
    v_rcp_f32 v20, v18
    v_rcp_f32 v21, v19
    v_exp_f32 v98, v130
    v_mfma_f32_32x32x16_bf16 v[208:223], v[88:91], v[76:79], v[208:223]
    v_exp_f32 v99, v131
    v_exp_f32 v100, v132
    v_exp_f32 v101, v133
    v_exp_f32 v102, v134
    v_mfma_f32_32x32x8_bf16 v[112:127], v[22:23], v[72:73], v[144:159]
    v_exp_f32 v103, v135
    v_exp_f32 v104, v136
    v_exp_f32 v105, v137
    v_exp_f32 v106, v138
    v_exp_f32 v107, v139
    v_exp_f32 v108, v140
    v_exp_f32 v109, v141
    v_add_u32 v3, v3, v29
    v_perm_b32 v26, v26, v26, v7
    v_pk_mul_f32 v[20:21], v[16:17], v[20:21]
    v_pk_add_f32 v[18:19], v[96:97], 1.0 op_sel_hi:[1,0]
    v_cvt_pk_bf16_f32 v80, v20, v21
    v_pk_fma_f32 v[16:17], v[128:129], v[98:99], v[128:129]
    v_pk_fma_f32 v[16:17], v[130:131], v[18:19], v[16:17]
    v_pk_fma_f32 v[18:19], v[18:19], v[98:99], v[18:19]
    v_pk_fma_f32 v[16:17], v[16:17], v[100:101], v[16:17]
    v_pk_fma_f32 v[16:17], v[132:133], v[18:19], v[16:17]
    v_pk_fma_f32 v[18:19], v[18:19], v[100:101], v[18:19]
    v_pk_fma_f32 v[16:17], v[16:17], v[102:103], v[16:17]
    v_pk_fma_f32 v[16:17], v[134:135], v[18:19], v[16:17]
    v_pk_fma_f32 v[18:19], v[18:19], v[102:103], v[18:19]
    v_pk_fma_f32 v[16:17], v[16:17], v[104:105], v[16:17]
    v_pk_fma_f32 v[16:17], v[136:137], v[18:19], v[16:17]
    v_pk_fma_f32 v[18:19], v[18:19], v[104:105], v[18:19]
    v_pk_fma_f32 v[16:17], v[16:17], v[106:107], v[16:17]
    v_pk_fma_f32 v[16:17], v[138:139], v[18:19], v[16:17]
    v_pk_fma_f32 v[18:19], v[18:19], v[106:107], v[18:19]
    v_exp_f32 v110, v142
    v_exp_f32 v111, v143
    v_pk_fma_f32 v[16:17], v[16:17], v[108:109], v[16:17]
    v_pk_fma_f32 v[16:17], v[140:141], v[18:19], v[16:17]
    v_pk_fma_f32 v[18:19], v[18:19], v[108:109], v[18:19]
    v_pk_fma_f32 v[16:17], v[16:17], v[110:111], v[16:17]
    v_pk_fma_f32 v[16:17], v[142:143], v[18:19], v[16:17]
    v_pk_fma_f32 v[18:19], v[18:19], v[110:111], v[18:19]
    v_mfma_f32_32x32x8_bf16 v[128:143], v[22:23], v[74:75], v[160:175]
    v_exp_f32 v96, v112
    v_exp_f32 v97, v113
    v_rcp_f32 v20, v18
    v_rcp_f32 v21, v19
    v_exp_f32 v98, v114
    v_exp_f32 v99, v115
    v_exp_f32 v100, v116
    v_exp_f32 v101, v117
    v_mad_u32_u24 v11, v10, v8, v9
    v_pk_mul_f32 v[20:21], v[16:17], v[20:21]
    v_pk_add_f32 v[18:19], v[96:97], 1.0 op_sel_hi:[1,0]
    v_cvt_pk_bf16_f32 v84, v20, v21
    v_pk_fma_f32 v[22:23], v[24:25], v[26:27], v[252:253] op_sel_hi:[1,0,1]
    v_pk_fma_f32 v[16:17], v[112:113], v[98:99], v[112:113]
    v_pk_fma_f32 v[16:17], v[114:115], v[18:19], v[16:17]
    v_pk_fma_f32 v[18:19], v[18:19], v[98:99], v[18:19]
    v_exp_f32 v102, v118
    v_exp_f32 v103, v119
    v_pk_fma_f32 v[16:17], v[16:17], v[100:101], v[16:17]
    v_pk_fma_f32 v[16:17], v[116:117], v[18:19], v[16:17]
    v_pk_fma_f32 v[18:19], v[18:19], v[100:101], v[18:19]
    v_exp_f32 v104, v120
    v_exp_f32 v105, v121
    v_pk_fma_f32 v[16:17], v[16:17], v[102:103], v[16:17]
    v_pk_fma_f32 v[16:17], v[118:119], v[18:19], v[16:17]
    v_pk_fma_f32 v[18:19], v[18:19], v[102:103], v[18:19]
    v_exp_f32 v106, v122
    v_exp_f32 v107, v123
    v_pk_fma_f32 v[16:17], v[16:17], v[104:105], v[16:17]
    v_pk_fma_f32 v[16:17], v[120:121], v[18:19], v[16:17]
    v_pk_fma_f32 v[18:19], v[18:19], v[104:105], v[18:19]
    v_exp_f32 v108, v124
    v_exp_f32 v109, v125
    v_pk_fma_f32 v[16:17], v[16:17], v[106:107], v[16:17]
    v_pk_fma_f32 v[16:17], v[122:123], v[18:19], v[16:17]
    v_pk_fma_f32 v[18:19], v[18:19], v[106:107], v[18:19]
    v_exp_f32 v110, v126
    v_exp_f32 v111, v127
    v_pk_fma_f32 v[16:17], v[16:17], v[108:109], v[16:17]
    v_pk_fma_f32 v[16:17], v[124:125], v[18:19], v[16:17]
    v_pk_fma_f32 v[18:19], v[18:19], v[108:109], v[18:19]
    v_pk_fma_f32 v[16:17], v[16:17], v[110:111], v[16:17]
    v_pk_fma_f32 v[16:17], v[126:127], v[18:19], v[16:17]
    v_pk_fma_f32 v[18:19], v[18:19], v[110:111], v[18:19]
    s_sub_u32 s61, s61, 1
    s_cbranch_scc1 TAILF0
    s_setprio 0
    s_waitcnt vmcnt(4)
    ds_read_u16_d16_hi v144, v1 offset:0
    ds_read_u16_d16_hi v145, v1 offset:256
    ds_read_u16_d16_hi v146, v1 offset:1024
    ds_read_u16_d16_hi v147, v1 offset:1280
    ds_read_u16_d16_hi v148, v1 offset:2048
    ds_read_u16_d16_hi v149, v1 offset:2304
    ds_read_u16_d16_hi v150, v1 offset:3072
    ds_read_u16_d16_hi v151, v1 offset:3328
    ds_read_u16_d16_hi v152, v1 offset:128
    ds_read_u16_d16_hi v153, v1 offset:384
    ds_read_u16_d16_hi v154, v1 offset:1152
    ds_read_u16_d16_hi v155, v1 offset:1408
    ds_read_u16_d16_hi v156, v1 offset:2176
    ds_read_u16_d16_hi v157, v1 offset:2432
    ds_read_u16_d16_hi v158, v1 offset:3200
    ds_read_u16_d16_hi v159, v1 offset:3456
    ds_read_u16_d16_hi v160, v1 offset:64
    ds_read_u16_d16_hi v161, v1 offset:320
    ds_read_u16_d16_hi v162, v1 offset:1088
    ds_read_u16_d16_hi v163, v1 offset:1344
    ds_read_u16_d16_hi v164, v1 offset:2112
    ds_read_u16_d16_hi v165, v1 offset:2368
    ds_read_u16_d16_hi v166, v1 offset:3136
    ds_read_u16_d16_hi v167, v1 offset:3392
    ds_read_u16_d16_hi v168, v1 offset:192
    ds_read_u16_d16_hi v169, v1 offset:448
    ds_read_u16_d16_hi v170, v1 offset:1216
    ds_read_u16_d16_hi v171, v1 offset:1472
    ds_read_u16_d16_hi v172, v1 offset:2240
    ds_read_u16_d16_hi v173, v1 offset:2496
    ds_read_u16_d16_hi v174, v1 offset:3264
    ds_read_u16_d16_hi v175, v1 offset:3520
    ds_read_b64_tr_b16 v[72:73], v11 offset:0
    ds_read_b64_tr_b16 v[74:75], v11 offset:64
    ds_read_u16 v64, v3 offset:0
    ds_read_u16 v66, v3 offset:4
    ds_read_u16 v68, v3 offset:8
    ds_read_u16 v70, v3 offset:12
    ds_read_u16 v4, v28 offset:32
    s_mov_b32 m0, s62
    s_waitcnt lgkmcnt(0)
    buffer_load_dwordx4 v[64:65], s[48:51], s52 idxen offen offset:0 sc1 lds
    buffer_load_dwordx4 v[66:67], s[48:51], s53 idxen offen offset:1024 sc1 lds
    buffer_load_dwordx4 v[68:69], s[48:51], s54 idxen offen offset:2048 sc1 lds
    buffer_load_dwordx4 v[70:71], s[48:51], s55 idxen offen offset:3072 sc1 lds
    v_exp_f32 v96, v128
    v_exp_f32 v97, v129
    v_mfma_f32_32x32x16_bf16 v[224:239], v[92:95], v[76:79], v[224:239]
    s_setprio 3
    v_rcp_f32 v20, v18
    v_rcp_f32 v21, v19
    v_exp_f32 v98, v130
    v_mfma_f32_32x32x8_bf16 v[112:127], v[22:23], v[72:73], v[144:159]
    v_exp_f32 v99, v131
    v_exp_f32 v100, v132
    v_exp_f32 v101, v133
    v_exp_f32 v102, v134
    v_exp_f32 v103, v135
    v_exp_f32 v104, v136
    v_exp_f32_e64 v105, v137
    v_pk_mul_f32 v[20:21], v[16:17], v[20:21]
    v_pk_add_f32 v[18:19], v[96:97], 1.0 op_sel_hi:[1,0]
    v_cvt_pk_bf16_f32 v88, v20, v21
    v_pk_fma_f32 v[16:17], v[128:129], v[98:99], v[128:129]
    v_pk_fma_f32 v[16:17], v[130:131], v[18:19], v[16:17]
    v_pk_fma_f32 v[18:19], v[18:19], v[98:99], v[18:19]
    v_pk_fma_f32 v[16:17], v[16:17], v[100:101], v[16:17]
    v_pk_fma_f32 v[16:17], v[132:133], v[18:19], v[16:17]
    v_pk_fma_f32 v[18:19], v[18:19], v[100:101], v[18:19]
    v_pk_fma_f32 v[16:17], v[16:17], v[102:103], v[16:17]
    v_pk_fma_f32 v[16:17], v[134:135], v[18:19], v[16:17]
    v_pk_fma_f32 v[18:19], v[18:19], v[102:103], v[18:19]
    v_exp_f32 v106, v138
    v_exp_f32 v107, v139
    v_pk_fma_f32 v[16:17], v[16:17], v[104:105], v[16:17]
    v_pk_fma_f32 v[16:17], v[136:137], v[18:19], v[16:17]
    v_pk_fma_f32 v[18:19], v[18:19], v[104:105], v[18:19]
    v_exp_f32 v108, v140
    v_exp_f32 v109, v141
    v_pk_fma_f32 v[16:17], v[16:17], v[106:107], v[16:17]
    v_pk_fma_f32 v[16:17], v[138:139], v[18:19], v[16:17]
    v_pk_fma_f32 v[18:19], v[18:19], v[106:107], v[18:19]
    v_exp_f32 v110, v142
    v_exp_f32 v111, v143
    v_pk_fma_f32 v[16:17], v[16:17], v[108:109], v[16:17]
    v_pk_fma_f32 v[16:17], v[140:141], v[18:19], v[16:17]
    v_pk_fma_f32 v[18:19], v[18:19], v[108:109], v[18:19]
    v_pk_fma_f32 v[16:17], v[16:17], v[110:111], v[16:17]
    v_pk_fma_f32 v[16:17], v[142:143], v[18:19], v[16:17]
    v_pk_fma_f32 v[18:19], v[18:19], v[110:111], v[18:19]
    v_mfma_f32_32x32x8_bf16 v[128:143], v[22:23], v[74:75], v[160:175]
    v_exp_f32 v96, v112
    v_exp_f32 v97, v113
    v_rcp_f32 v20, v18
    v_rcp_f32 v21, v19
    v_exp_f32 v98, v114
    v_exp_f32 v99, v115
    v_exp_f32 v100, v116
    v_exp_f32 v101, v117
    v_add_u32_e64 v4, v4, v30
    v_pk_mul_f32 v[20:21], v[16:17], v[20:21]
    v_pk_add_f32 v[18:19], v[96:97], 1.0 op_sel_hi:[1,0]
    v_cvt_pk_bf16_f32 v92, v20, v21
    v_pk_fma_f32 v[16:17], v[112:113], v[98:99], v[112:113]
    v_pk_fma_f32 v[16:17], v[114:115], v[18:19], v[16:17]
    v_pk_fma_f32 v[18:19], v[18:19], v[98:99], v[18:19]
    v_exp_f32 v102, v118
    v_exp_f32 v103, v119
    v_pk_fma_f32 v[16:17], v[16:17], v[100:101], v[16:17]
    v_pk_fma_f32 v[16:17], v[116:117], v[18:19], v[16:17]
    v_pk_fma_f32 v[18:19], v[18:19], v[100:101], v[18:19]
    v_exp_f32 v104, v120
    v_exp_f32 v105, v121
    v_pk_fma_f32 v[16:17], v[16:17], v[102:103], v[16:17]
    v_pk_fma_f32 v[16:17], v[118:119], v[18:19], v[16:17]
    v_pk_fma_f32 v[18:19], v[18:19], v[102:103], v[18:19]
    v_exp_f32 v106, v122
    v_exp_f32 v107, v123
    v_pk_fma_f32 v[16:17], v[16:17], v[104:105], v[16:17]
    v_pk_fma_f32 v[16:17], v[120:121], v[18:19], v[16:17]
    v_pk_fma_f32 v[18:19], v[18:19], v[104:105], v[18:19]
    v_exp_f32 v108, v124
    v_exp_f32 v109, v125
    v_pk_fma_f32 v[16:17], v[16:17], v[106:107], v[16:17]
    v_pk_fma_f32 v[16:17], v[122:123], v[18:19], v[16:17]
    v_pk_fma_f32 v[18:19], v[18:19], v[106:107], v[18:19]
    v_exp_f32 v110, v126
    v_exp_f32 v111, v127
    v_pk_fma_f32 v[16:17], v[16:17], v[108:109], v[16:17]
    v_pk_fma_f32 v[16:17], v[124:125], v[18:19], v[16:17]
    v_pk_fma_f32 v[18:19], v[18:19], v[108:109], v[18:19]
    v_pk_fma_f32 v[16:17], v[16:17], v[110:111], v[16:17]
    v_pk_fma_f32 v[16:17], v[126:127], v[18:19], v[16:17]
    v_pk_fma_f32 v[18:19], v[18:19], v[110:111], v[18:19]
SLOTF1:
    s_setprio 0
    s_waitcnt vmcnt(4)
    ds_read_u16_d16_hi v144, v1 offset:4096
    ds_read_u16_d16_hi v145, v1 offset:4352
    ds_read_u16_d16_hi v146, v1 offset:5120
    ds_read_u16_d16_hi v147, v1 offset:5376
    ds_read_u16_d16_hi v148, v1 offset:6144
    ds_read_u16_d16_hi v149, v1 offset:6400
    ds_read_u16_d16_hi v150, v1 offset:7168
    ds_read_u16_d16_hi v151, v1 offset:7424
    ds_read_u16_d16_hi v152, v1 offset:4224
    ds_read_u16_d16_hi v153, v1 offset:4480
    ds_read_u16_d16_hi v154, v1 offset:5248
    ds_read_u16_d16_hi v155, v1 offset:5504
    ds_read_u16_d16_hi v156, v1 offset:6272
    ds_read_u16_d16_hi v157, v1 offset:6528
    ds_read_u16_d16_hi v158, v1 offset:7296
    ds_read_u16_d16_hi v159, v1 offset:7552
    ds_read_u16_d16_hi v160, v1 offset:4160
    ds_read_u16_d16_hi v161, v1 offset:4416
    ds_read_u16_d16_hi v162, v1 offset:5184
    ds_read_u16_d16_hi v163, v1 offset:5440
    ds_read_u16_d16_hi v164, v1 offset:6208
    ds_read_u16_d16_hi v165, v1 offset:6464
    ds_read_u16_d16_hi v166, v1 offset:7232
    ds_read_u16_d16_hi v167, v1 offset:7488
    ds_read_u16_d16_hi v168, v1 offset:4288
    ds_read_u16_d16_hi v169, v1 offset:4544
    ds_read_u16_d16_hi v170, v1 offset:5312
    ds_read_u16_d16_hi v171, v1 offset:5568
    ds_read_u16_d16_hi v172, v1 offset:6336
    ds_read_u16_d16_hi v173, v1 offset:6592
    ds_read_u16_d16_hi v174, v1 offset:7360
    ds_read_u16_d16_hi v175, v1 offset:7616
    ds_read_b64_tr_b16 v[72:73], v11 offset:128
    ds_read_b64_tr_b16 v[74:75], v11 offset:192
    ds_read_u16 v3, v15 offset:48
    ds_read_b32 v26, v4
    ds_read_u16 v10, v5 offset:34
    ds_read_b32 v76, v6
    ds_read_b32 v77, v6 offset:128
    s_mov_b32 m0, s63
    s_cmp_eq_u32 s61, 0
    s_waitcnt lgkmcnt(0)
    s_cbranch_scc1 SKDF1
    buffer_load_dwordx4 v[64:65], s[48:51], s56 idxen offen offset:0 sc1 lds
    buffer_load_dwordx4 v[66:67], s[48:51], s57 idxen offen offset:1024 sc1 lds
    buffer_load_dwordx4 v[68:69], s[48:51], s58 idxen offen offset:2048 sc1 lds
    buffer_load_dwordx4 v[70:71], s[48:51], s59 idxen offen offset:3072 sc1 lds
SKDF1:
    v_exp_f32 v96, v128
    s_setprio 3
    v_mfma_f32_32x32x8_bf16 v[112:127], v[22:23], v[72:73], v[144:159]
    v_exp_f32 v97, v129
    v_rcp_f32 v20, v18
    v_rcp_f32 v21, v19
    v_exp_f32 v98, v130
    v_exp_f32 v99, v131
    v_exp_f32 v100, v132
    v_exp_f32 v101, v133
    v_add_u32 v3, v3, v29
    v_perm_b32 v26, v26, v26, v7
    v_pk_mul_f32 v[20:21], v[16:17], v[20:21]
    v_pk_add_f32 v[18:19], v[96:97], 1.0 op_sel_hi:[1,0]
    v_cvt_pk_bf16_f32 v81, v20, v21
    v_pk_fma_f32 v[16:17], v[128:129], v[98:99], v[128:129]
    v_pk_fma_f32 v[16:17], v[130:131], v[18:19], v[16:17]
    v_pk_fma_f32 v[18:19], v[18:19], v[98:99], v[18:19]
    v_exp_f32 v102, v134
    v_exp_f32 v103, v135
    v_pk_fma_f32 v[16:17], v[16:17], v[100:101], v[16:17]
    v_pk_fma_f32 v[16:17], v[132:133], v[18:19], v[16:17]
    v_pk_fma_f32 v[18:19], v[18:19], v[100:101], v[18:19]
    v_exp_f32 v104, v136
    v_exp_f32 v105, v137
    v_pk_fma_f32 v[16:17], v[16:17], v[102:103], v[16:17]
    v_pk_fma_f32 v[16:17], v[134:135], v[18:19], v[16:17]
    v_pk_fma_f32 v[18:19], v[18:19], v[102:103], v[18:19]
    v_exp_f32 v106, v138
    v_exp_f32 v107, v139
    v_pk_fma_f32 v[16:17], v[16:17], v[104:105], v[16:17]
    v_pk_fma_f32 v[16:17], v[136:137], v[18:19], v[16:17]
    v_pk_fma_f32 v[18:19], v[18:19], v[104:105], v[18:19]
    v_exp_f32 v108, v140
    v_exp_f32 v109, v141
    v_pk_fma_f32 v[16:17], v[16:17], v[106:107], v[16:17]
    v_pk_fma_f32 v[16:17], v[138:139], v[18:19], v[16:17]
    v_pk_fma_f32 v[18:19], v[18:19], v[106:107], v[18:19]
    v_exp_f32 v110, v142
    v_exp_f32 v111, v143
    v_pk_fma_f32 v[16:17], v[16:17], v[108:109], v[16:17]
    v_pk_fma_f32 v[16:17], v[140:141], v[18:19], v[16:17]
    v_pk_fma_f32 v[18:19], v[18:19], v[108:109], v[18:19]
    v_pk_fma_f32 v[16:17], v[16:17], v[110:111], v[16:17]
    v_pk_fma_f32 v[16:17], v[142:143], v[18:19], v[16:17]
    v_pk_fma_f32 v[18:19], v[18:19], v[110:111], v[18:19]
    v_mfma_f32_32x32x8_bf16 v[128:143], v[22:23], v[74:75], v[160:175]
    v_exp_f32 v96, v112
    v_exp_f32 v97, v113
    v_rcp_f32 v20, v18
    v_rcp_f32 v21, v19
    v_exp_f32 v98, v114
    v_exp_f32 v99, v115
    v_exp_f32 v100, v116
    v_exp_f32 v101, v117
    v_mad_u32_u24 v11, v10, v8, v9
    v_pk_mul_f32 v[20:21], v[16:17], v[20:21]
    v_pk_add_f32 v[18:19], v[96:97], 1.0 op_sel_hi:[1,0]
    v_cvt_pk_bf16_f32 v85, v20, v21
    v_pk_fma_f32 v[22:23], v[24:25], v[26:27], v[252:253] op_sel_hi:[1,0,1]
    v_pk_fma_f32 v[16:17], v[112:113], v[98:99], v[112:113]
    v_pk_fma_f32 v[16:17], v[114:115], v[18:19], v[16:17]
    v_pk_fma_f32 v[18:19], v[18:19], v[98:99], v[18:19]
    v_exp_f32 v102, v118
    v_exp_f32 v103, v119
    v_pk_fma_f32 v[16:17], v[16:17], v[100:101], v[16:17]
    v_pk_fma_f32 v[16:17], v[116:117], v[18:19], v[16:17]
    v_pk_fma_f32 v[18:19], v[18:19], v[100:101], v[18:19]
    v_exp_f32 v104, v120
    v_exp_f32 v105, v121
    v_pk_fma_f32 v[16:17], v[16:17], v[102:103], v[16:17]
    v_pk_fma_f32 v[16:17], v[118:119], v[18:19], v[16:17]
    v_pk_fma_f32 v[18:19], v[18:19], v[102:103], v[18:19]
    v_exp_f32 v106, v122
    v_exp_f32 v107, v123
    v_pk_fma_f32 v[16:17], v[16:17], v[104:105], v[16:17]
    v_pk_fma_f32 v[16:17], v[120:121], v[18:19], v[16:17]
    v_pk_fma_f32 v[18:19], v[18:19], v[104:105], v[18:19]
    v_exp_f32 v108, v124
    v_exp_f32 v109, v125
    v_pk_fma_f32 v[16:17], v[16:17], v[106:107], v[16:17]
    v_pk_fma_f32 v[16:17], v[122:123], v[18:19], v[16:17]
    v_pk_fma_f32 v[18:19], v[18:19], v[106:107], v[18:19]
    v_exp_f32 v110, v126
    v_exp_f32 v111, v127
    v_pk_fma_f32 v[16:17], v[16:17], v[108:109], v[16:17]
    v_pk_fma_f32 v[16:17], v[124:125], v[18:19], v[16:17]
    v_pk_fma_f32 v[18:19], v[18:19], v[108:109], v[18:19]
    v_pk_fma_f32 v[16:17], v[16:17], v[110:111], v[16:17]
    v_pk_fma_f32 v[16:17], v[126:127], v[18:19], v[16:17]
    v_pk_fma_f32 v[18:19], v[18:19], v[110:111], v[18:19]
    s_sub_u32 s61, s61, 1
    s_cbranch_scc1 TAILF1
    s_setprio 0
    s_waitcnt vmcnt(4)
    ds_read_u16_d16_hi v144, v1 offset:0
    ds_read_u16_d16_hi v145, v1 offset:256
    ds_read_u16_d16_hi v146, v1 offset:1024
    ds_read_u16_d16_hi v147, v1 offset:1280
    ds_read_u16_d16_hi v148, v1 offset:2048
    ds_read_u16_d16_hi v149, v1 offset:2304
    ds_read_u16_d16_hi v150, v1 offset:3072
    ds_read_u16_d16_hi v151, v1 offset:3328
    ds_read_u16_d16_hi v152, v1 offset:128
    ds_read_u16_d16_hi v153, v1 offset:384
    ds_read_u16_d16_hi v154, v1 offset:1152
    ds_read_u16_d16_hi v155, v1 offset:1408
    ds_read_u16_d16_hi v156, v1 offset:2176
    ds_read_u16_d16_hi v157, v1 offset:2432
    ds_read_u16_d16_hi v158, v1 offset:3200
    ds_read_u16_d16_hi v159, v1 offset:3456
    ds_read_u16_d16_hi v160, v1 offset:64
    ds_read_u16_d16_hi v161, v1 offset:320
    ds_read_u16_d16_hi v162, v1 offset:1088
    ds_read_u16_d16_hi v163, v1 offset:1344
    ds_read_u16_d16_hi v164, v1 offset:2112
    ds_read_u16_d16_hi v165, v1 offset:2368
    ds_read_u16_d16_hi v166, v1 offset:3136
    ds_read_u16_d16_hi v167, v1 offset:3392
    ds_read_u16_d16_hi v168, v1 offset:192
    ds_read_u16_d16_hi v169, v1 offset:448
    ds_read_u16_d16_hi v170, v1 offset:1216
    ds_read_u16_d16_hi v171, v1 offset:1472
    ds_read_u16_d16_hi v172, v1 offset:2240
    ds_read_u16_d16_hi v173, v1 offset:2496
    ds_read_u16_d16_hi v174, v1 offset:3264
    ds_read_u16_d16_hi v175, v1 offset:3520
    ds_read_b64_tr_b16 v[72:73], v11 offset:0
    ds_read_b64_tr_b16 v[74:75], v11 offset:64
    ds_read_u16 v64, v3 offset:0
    ds_read_u16 v66, v3 offset:4
    ds_read_u16 v68, v3 offset:8
    ds_read_u16 v70, v3 offset:12
    ds_read_u16 v4, v28 offset:48
    s_mov_b32 m0, s62
    s_waitcnt lgkmcnt(0)
    buffer_load_dwordx4 v[64:65], s[48:51], s52 idxen offen offset:0 sc1 lds
    buffer_load_dwordx4 v[66:67], s[48:51], s53 idxen offen offset:1024 sc1 lds
    buffer_load_dwordx4 v[68:69], s[48:51], s54 idxen offen offset:2048 sc1 lds
    buffer_load_dwordx4 v[70:71], s[48:51], s55 idxen offen offset:3072 sc1 lds
    v_exp_f32 v96, v128
    s_setprio 3
    v_mfma_f32_32x32x8_bf16 v[112:127], v[22:23], v[72:73], v[144:159]
    v_exp_f32 v97, v129
    v_rcp_f32 v20, v18
    v_rcp_f32 v21, v19
    v_exp_f32 v98, v130
    v_exp_f32 v99, v131
    v_exp_f32 v100, v132
    v_exp_f32_e64 v101, v133
    v_pk_mul_f32 v[20:21], v[16:17], v[20:21]
    v_pk_add_f32 v[18:19], v[96:97], 1.0 op_sel_hi:[1,0]
    v_cvt_pk_bf16_f32 v89, v20, v21
    v_pk_fma_f32 v[16:17], v[128:129], v[98:99], v[128:129]
    v_pk_fma_f32 v[16:17], v[130:131], v[18:19], v[16:17]
    v_pk_fma_f32 v[18:19], v[18:19], v[98:99], v[18:19]
    v_exp_f32 v102, v134
    v_exp_f32 v103, v135
    v_pk_fma_f32 v[16:17], v[16:17], v[100:101], v[16:17]
    v_pk_fma_f32 v[16:17], v[132:133], v[18:19], v[16:17]
    v_pk_fma_f32 v[18:19], v[18:19], v[100:101], v[18:19]
    v_exp_f32 v104, v136
    v_exp_f32 v105, v137
    v_pk_fma_f32 v[16:17], v[16:17], v[102:103], v[16:17]
    v_pk_fma_f32 v[16:17], v[134:135], v[18:19], v[16:17]
    v_pk_fma_f32 v[18:19], v[18:19], v[102:103], v[18:19]
    v_exp_f32 v106, v138
    v_exp_f32 v107, v139
    v_pk_fma_f32 v[16:17], v[16:17], v[104:105], v[16:17]
    v_pk_fma_f32 v[16:17], v[136:137], v[18:19], v[16:17]
    v_pk_fma_f32 v[18:19], v[18:19], v[104:105], v[18:19]
    v_exp_f32 v108, v140
    v_exp_f32 v109, v141
    v_pk_fma_f32 v[16:17], v[16:17], v[106:107], v[16:17]
    v_pk_fma_f32 v[16:17], v[138:139], v[18:19], v[16:17]
    v_pk_fma_f32 v[18:19], v[18:19], v[106:107], v[18:19]
    v_exp_f32 v110, v142
    v_exp_f32 v111, v143
    v_pk_fma_f32 v[16:17], v[16:17], v[108:109], v[16:17]
    v_pk_fma_f32 v[16:17], v[140:141], v[18:19], v[16:17]
    v_pk_fma_f32 v[18:19], v[18:19], v[108:109], v[18:19]
    v_pk_fma_f32 v[16:17], v[16:17], v[110:111], v[16:17]
    v_pk_fma_f32 v[16:17], v[142:143], v[18:19], v[16:17]
    v_pk_fma_f32 v[18:19], v[18:19], v[110:111], v[18:19]
    v_mfma_f32_32x32x8_bf16 v[128:143], v[22:23], v[74:75], v[160:175]
    v_exp_f32 v96, v112
    v_exp_f32 v97, v113
    v_rcp_f32 v20, v18
    v_rcp_f32 v21, v19
    v_exp_f32 v98, v114
    v_exp_f32 v99, v115
    v_exp_f32 v100, v116
    v_exp_f32 v101, v117
    v_add_u32_e64 v4, v4, v30
    v_pk_mul_f32 v[20:21], v[16:17], v[20:21]
    v_pk_add_f32 v[18:19], v[96:97], 1.0 op_sel_hi:[1,0]
    v_cvt_pk_bf16_f32 v93, v20, v21
    v_pk_fma_f32 v[16:17], v[112:113], v[98:99], v[112:113]
    v_pk_fma_f32 v[16:17], v[114:115], v[18:19], v[16:17]
    v_pk_fma_f32 v[18:19], v[18:19], v[98:99], v[18:19]
    v_exp_f32 v102, v118
    v_exp_f32 v103, v119
    v_pk_fma_f32 v[16:17], v[16:17], v[100:101], v[16:17]
    v_pk_fma_f32 v[16:17], v[116:117], v[18:19], v[16:17]
    v_pk_fma_f32 v[18:19], v[18:19], v[100:101], v[18:19]
    v_exp_f32 v104, v120
    v_exp_f32 v105, v121
    v_pk_fma_f32 v[16:17], v[16:17], v[102:103], v[16:17]
    v_pk_fma_f32 v[16:17], v[118:119], v[18:19], v[16:17]
    v_pk_fma_f32 v[18:19], v[18:19], v[102:103], v[18:19]
    v_exp_f32 v106, v122
    v_exp_f32 v107, v123
    v_pk_fma_f32 v[16:17], v[16:17], v[104:105], v[16:17]
    v_pk_fma_f32 v[16:17], v[120:121], v[18:19], v[16:17]
    v_pk_fma_f32 v[18:19], v[18:19], v[104:105], v[18:19]
    v_exp_f32 v108, v124
    v_exp_f32 v109, v125
    v_pk_fma_f32 v[16:17], v[16:17], v[106:107], v[16:17]
    v_pk_fma_f32 v[16:17], v[122:123], v[18:19], v[16:17]
    v_pk_fma_f32 v[18:19], v[18:19], v[106:107], v[18:19]
    v_exp_f32 v110, v126
    v_exp_f32 v111, v127
    v_pk_fma_f32 v[16:17], v[16:17], v[108:109], v[16:17]
    v_pk_fma_f32 v[16:17], v[124:125], v[18:19], v[16:17]
    v_pk_fma_f32 v[18:19], v[18:19], v[108:109], v[18:19]
    v_pk_fma_f32 v[16:17], v[16:17], v[110:111], v[16:17]
    v_pk_fma_f32 v[16:17], v[126:127], v[18:19], v[16:17]
    v_pk_fma_f32 v[18:19], v[18:19], v[110:111], v[18:19]
SLOTF2:
    s_setprio 0
    s_waitcnt vmcnt(4)
    ds_read_u16_d16_hi v144, v1 offset:4096
    ds_read_u16_d16_hi v145, v1 offset:4352
    ds_read_u16_d16_hi v146, v1 offset:5120
    ds_read_u16_d16_hi v147, v1 offset:5376
    ds_read_u16_d16_hi v148, v1 offset:6144
    ds_read_u16_d16_hi v149, v1 offset:6400
    ds_read_u16_d16_hi v150, v1 offset:7168
    ds_read_u16_d16_hi v151, v1 offset:7424
    ds_read_u16_d16_hi v152, v1 offset:4224
    ds_read_u16_d16_hi v153, v1 offset:4480
    ds_read_u16_d16_hi v154, v1 offset:5248
    ds_read_u16_d16_hi v155, v1 offset:5504
    ds_read_u16_d16_hi v156, v1 offset:6272
    ds_read_u16_d16_hi v157, v1 offset:6528
    ds_read_u16_d16_hi v158, v1 offset:7296
    ds_read_u16_d16_hi v159, v1 offset:7552
    ds_read_u16_d16_hi v160, v1 offset:4160
    ds_read_u16_d16_hi v161, v1 offset:4416
    ds_read_u16_d16_hi v162, v1 offset:5184
    ds_read_u16_d16_hi v163, v1 offset:5440
    ds_read_u16_d16_hi v164, v1 offset:6208
    ds_read_u16_d16_hi v165, v1 offset:6464
    ds_read_u16_d16_hi v166, v1 offset:7232
    ds_read_u16_d16_hi v167, v1 offset:7488
    ds_read_u16_d16_hi v168, v1 offset:4288
    ds_read_u16_d16_hi v169, v1 offset:4544
    ds_read_u16_d16_hi v170, v1 offset:5312
    ds_read_u16_d16_hi v171, v1 offset:5568
    ds_read_u16_d16_hi v172, v1 offset:6336
    ds_read_u16_d16_hi v173, v1 offset:6592
    ds_read_u16_d16_hi v174, v1 offset:7360
    ds_read_u16_d16_hi v175, v1 offset:7616
    ds_read_b64_tr_b16 v[72:73], v11 offset:128
    ds_read_b64_tr_b16 v[74:75], v11 offset:192
    ds_read_u16 v3, v15 offset:64
    ds_read_b32 v26, v4
    ds_read_u16 v10, v5 offset:50
    ds_read_b32 v78, v6 offset:256
    s_mov_b32 m0, s63
    s_cmp_eq_u32 s61, 0
    s_waitcnt lgkmcnt(0)
    s_cbranch_scc1 SKDF2
    buffer_load_dwordx4 v[64:65], s[48:51], s56 idxen offen offset:0 sc1 lds
    buffer_load_dwordx4 v[66:67], s[48:51], s57 idxen offen offset:1024 sc1 lds
    buffer_load_dwordx4 v[68:69], s[48:51], s58 idxen offen offset:2048 sc1 lds
    buffer_load_dwordx4 v[70:71], s[48:51], s59 idxen offen offset:3072 sc1 lds
SKDF2:
    v_exp_f32 v96, v128
    s_setprio 3
    v_mfma_f32_32x32x8_bf16 v[112:127], v[22:23], v[72:73], v[144:159]
    v_exp_f32 v97, v129
    v_rcp_f32 v20, v18
    v_rcp_f32 v21, v19
    v_exp_f32 v98, v130
    v_exp_f32 v99, v131
    v_exp_f32 v100, v132
    v_exp_f32 v101, v133
    v_add_u32 v3, v3, v29
    v_perm_b32 v26, v26, v26, v7
    v_pk_mul_f32 v[20:21], v[16:17], v[20:21]
    v_pk_add_f32 v[18:19], v[96:97], 1.0 op_sel_hi:[1,0]
    v_cvt_pk_bf16_f32 v82, v20, v21
    v_pk_fma_f32 v[16:17], v[128:129], v[98:99], v[128:129]
    v_pk_fma_f32 v[16:17], v[130:131], v[18:19], v[16:17]
    v_pk_fma_f32 v[18:19], v[18:19], v[98:99], v[18:19]
    v_exp_f32 v102, v134
    v_exp_f32 v103, v135
    v_pk_fma_f32 v[16:17], v[16:17], v[100:101], v[16:17]
    v_pk_fma_f32 v[16:17], v[132:133], v[18:19], v[16:17]
    v_pk_fma_f32 v[18:19], v[18:19], v[100:101], v[18:19]
    v_exp_f32 v104, v136
    v_exp_f32 v105, v137
    v_pk_fma_f32 v[16:17], v[16:17], v[102:103], v[16:17]
    v_pk_fma_f32 v[16:17], v[134:135], v[18:19], v[16:17]
    v_pk_fma_f32 v[18:19], v[18:19], v[102:103], v[18:19]
    v_exp_f32 v106, v138
    v_exp_f32 v107, v139
    v_pk_fma_f32 v[16:17], v[16:17], v[104:105], v[16:17]
    v_pk_fma_f32 v[16:17], v[136:137], v[18:19], v[16:17]
    v_pk_fma_f32 v[18:19], v[18:19], v[104:105], v[18:19]
    v_exp_f32 v108, v140
    v_exp_f32 v109, v141
    v_pk_fma_f32 v[16:17], v[16:17], v[106:107], v[16:17]
    v_pk_fma_f32 v[16:17], v[138:139], v[18:19], v[16:17]
    v_pk_fma_f32 v[18:19], v[18:19], v[106:107], v[18:19]
    v_exp_f32 v110, v142
    v_exp_f32 v111, v143
    v_pk_fma_f32 v[16:17], v[16:17], v[108:109], v[16:17]
    v_pk_fma_f32 v[16:17], v[140:141], v[18:19], v[16:17]
    v_pk_fma_f32 v[18:19], v[18:19], v[108:109], v[18:19]
    v_pk_fma_f32 v[16:17], v[16:17], v[110:111], v[16:17]
    v_pk_fma_f32 v[16:17], v[142:143], v[18:19], v[16:17]
    v_pk_fma_f32 v[18:19], v[18:19], v[110:111], v[18:19]
    v_mfma_f32_32x32x8_bf16 v[128:143], v[22:23], v[74:75], v[160:175]
    v_exp_f32 v96, v112
    v_exp_f32 v97, v113
    v_rcp_f32 v20, v18
    v_rcp_f32 v21, v19
    v_exp_f32 v98, v114
    v_exp_f32 v99, v115
    v_exp_f32 v100, v116
    v_exp_f32 v101, v117
    v_mad_u32_u24 v11, v10, v8, v9
    v_pk_mul_f32 v[20:21], v[16:17], v[20:21]
    v_pk_add_f32 v[18:19], v[96:97], 1.0 op_sel_hi:[1,0]
    v_cvt_pk_bf16_f32 v86, v20, v21
    v_pk_fma_f32 v[22:23], v[24:25], v[26:27], v[252:253] op_sel_hi:[1,0,1]
    v_pk_fma_f32 v[16:17], v[112:113], v[98:99], v[112:113]
    v_pk_fma_f32 v[16:17], v[114:115], v[18:19], v[16:17]
    v_pk_fma_f32 v[18:19], v[18:19], v[98:99], v[18:19]
    v_exp_f32 v102, v118
    v_exp_f32 v103, v119
    v_pk_fma_f32 v[16:17], v[16:17], v[100:101], v[16:17]
    v_pk_fma_f32 v[16:17], v[116:117], v[18:19], v[16:17]
    v_pk_fma_f32 v[18:19], v[18:19], v[100:101], v[18:19]
    v_exp_f32 v104, v120
    v_exp_f32 v105, v121
    v_pk_fma_f32 v[16:17], v[16:17], v[102:103], v[16:17]
    v_pk_fma_f32 v[16:17], v[118:119], v[18:19], v[16:17]
    v_pk_fma_f32 v[18:19], v[18:19], v[102:103], v[18:19]
    v_exp_f32 v106, v122
    v_exp_f32 v107, v123
    v_pk_fma_f32 v[16:17], v[16:17], v[104:105], v[16:17]
    v_pk_fma_f32 v[16:17], v[120:121], v[18:19], v[16:17]
    v_pk_fma_f32 v[18:19], v[18:19], v[104:105], v[18:19]
    v_exp_f32 v108, v124
    v_exp_f32 v109, v125
    v_pk_fma_f32 v[16:17], v[16:17], v[106:107], v[16:17]
    v_pk_fma_f32 v[16:17], v[122:123], v[18:19], v[16:17]
    v_pk_fma_f32 v[18:19], v[18:19], v[106:107], v[18:19]
    v_exp_f32 v110, v126
    v_exp_f32 v111, v127
    v_pk_fma_f32 v[16:17], v[16:17], v[108:109], v[16:17]
    v_pk_fma_f32 v[16:17], v[124:125], v[18:19], v[16:17]
    v_pk_fma_f32 v[18:19], v[18:19], v[108:109], v[18:19]
    v_pk_fma_f32 v[16:17], v[16:17], v[110:111], v[16:17]
    v_pk_fma_f32 v[16:17], v[126:127], v[18:19], v[16:17]
    v_pk_fma_f32 v[18:19], v[18:19], v[110:111], v[18:19]
    s_sub_u32 s61, s61, 1
    s_cbranch_scc1 TAILF2
    s_setprio 0
    s_waitcnt vmcnt(4)
    ds_read_u16_d16_hi v144, v1 offset:0
    ds_read_u16_d16_hi v145, v1 offset:256
    ds_read_u16_d16_hi v146, v1 offset:1024
    ds_read_u16_d16_hi v147, v1 offset:1280
    ds_read_u16_d16_hi v148, v1 offset:2048
    ds_read_u16_d16_hi v149, v1 offset:2304
    ds_read_u16_d16_hi v150, v1 offset:3072
    ds_read_u16_d16_hi v151, v1 offset:3328
    ds_read_u16_d16_hi v152, v1 offset:128
    ds_read_u16_d16_hi v153, v1 offset:384
    ds_read_u16_d16_hi v154, v1 offset:1152
    ds_read_u16_d16_hi v155, v1 offset:1408
    ds_read_u16_d16_hi v156, v1 offset:2176
    ds_read_u16_d16_hi v157, v1 offset:2432
    ds_read_u16_d16_hi v158, v1 offset:3200
    ds_read_u16_d16_hi v159, v1 offset:3456
    ds_read_u16_d16_hi v160, v1 offset:64
    ds_read_u16_d16_hi v161, v1 offset:320
    ds_read_u16_d16_hi v162, v1 offset:1088
    ds_read_u16_d16_hi v163, v1 offset:1344
    ds_read_u16_d16_hi v164, v1 offset:2112
    ds_read_u16_d16_hi v165, v1 offset:2368
    ds_read_u16_d16_hi v166, v1 offset:3136
    ds_read_u16_d16_hi v167, v1 offset:3392
    ds_read_u16_d16_hi v168, v1 offset:192
    ds_read_u16_d16_hi v169, v1 offset:448
    ds_read_u16_d16_hi v170, v1 offset:1216
    ds_read_u16_d16_hi v171, v1 offset:1472
    ds_read_u16_d16_hi v172, v1 offset:2240
    ds_read_u16_d16_hi v173, v1 offset:2496
    ds_read_u16_d16_hi v174, v1 offset:3264
    ds_read_u16_d16_hi v175, v1 offset:3520
    ds_read_b64_tr_b16 v[72:73], v11 offset:0
    ds_read_b64_tr_b16 v[74:75], v11 offset:64
    ds_read_u16 v64, v3 offset:0
    ds_read_u16 v66, v3 offset:4
    ds_read_u16 v68, v3 offset:8
    ds_read_u16 v70, v3 offset:12
    ds_read_u16 v4, v28 offset:64
    s_mov_b32 m0, s62
    s_waitcnt lgkmcnt(0)
    buffer_load_dwordx4 v[64:65], s[48:51], s52 idxen offen offset:0 sc1 lds
    buffer_load_dwordx4 v[66:67], s[48:51], s53 idxen offen offset:1024 sc1 lds
    buffer_load_dwordx4 v[68:69], s[48:51], s54 idxen offen offset:2048 sc1 lds
    buffer_load_dwordx4 v[70:71], s[48:51], s55 idxen offen offset:3072 sc1 lds
    v_exp_f32 v96, v128
    s_setprio 3
    v_mfma_f32_32x32x8_bf16 v[112:127], v[22:23], v[72:73], v[144:159]
    v_exp_f32 v97, v129
    v_rcp_f32 v20, v18
    v_rcp_f32 v21, v19
    v_exp_f32 v98, v130
    v_exp_f32 v99, v131
    v_exp_f32 v100, v132
    v_exp_f32_e64 v101, v133
    v_pk_mul_f32 v[20:21], v[16:17], v[20:21]
    v_pk_add_f32 v[18:19], v[96:97], 1.0 op_sel_hi:[1,0]
    v_cvt_pk_bf16_f32 v90, v20, v21
    v_pk_fma_f32 v[16:17], v[128:129], v[98:99], v[128:129]
    v_pk_fma_f32 v[16:17], v[130:131], v[18:19], v[16:17]
    v_pk_fma_f32 v[18:19], v[18:19], v[98:99], v[18:19]
    v_exp_f32 v102, v134
    v_exp_f32 v103, v135
    v_pk_fma_f32 v[16:17], v[16:17], v[100:101], v[16:17]
    v_pk_fma_f32 v[16:17], v[132:133], v[18:19], v[16:17]
    v_pk_fma_f32 v[18:19], v[18:19], v[100:101], v[18:19]
    v_exp_f32 v104, v136
    v_exp_f32 v105, v137
    v_pk_fma_f32 v[16:17], v[16:17], v[102:103], v[16:17]
    v_pk_fma_f32 v[16:17], v[134:135], v[18:19], v[16:17]
    v_pk_fma_f32 v[18:19], v[18:19], v[102:103], v[18:19]
    v_exp_f32 v106, v138
    v_exp_f32 v107, v139
    v_pk_fma_f32 v[16:17], v[16:17], v[104:105], v[16:17]
    v_pk_fma_f32 v[16:17], v[136:137], v[18:19], v[16:17]
    v_pk_fma_f32 v[18:19], v[18:19], v[104:105], v[18:19]
    v_exp_f32 v108, v140
    v_exp_f32 v109, v141
    v_pk_fma_f32 v[16:17], v[16:17], v[106:107], v[16:17]
    v_pk_fma_f32 v[16:17], v[138:139], v[18:19], v[16:17]
    v_pk_fma_f32 v[18:19], v[18:19], v[106:107], v[18:19]
    v_exp_f32 v110, v142
    v_exp_f32 v111, v143
    v_pk_fma_f32 v[16:17], v[16:17], v[108:109], v[16:17]
    v_pk_fma_f32 v[16:17], v[140:141], v[18:19], v[16:17]
    v_pk_fma_f32 v[18:19], v[18:19], v[108:109], v[18:19]
    v_pk_fma_f32 v[16:17], v[16:17], v[110:111], v[16:17]
    v_pk_fma_f32 v[16:17], v[142:143], v[18:19], v[16:17]
    v_pk_fma_f32 v[18:19], v[18:19], v[110:111], v[18:19]
    v_mfma_f32_32x32x8_bf16 v[128:143], v[22:23], v[74:75], v[160:175]
    v_exp_f32 v96, v112
    v_exp_f32 v97, v113
    v_rcp_f32 v20, v18
    v_rcp_f32 v21, v19
    v_exp_f32 v98, v114
    v_exp_f32 v99, v115
    v_exp_f32 v100, v116
    v_exp_f32 v101, v117
    v_add_u32_e64 v4, v4, v30
    v_pk_mul_f32 v[20:21], v[16:17], v[20:21]
    v_pk_add_f32 v[18:19], v[96:97], 1.0 op_sel_hi:[1,0]
    v_cvt_pk_bf16_f32 v94, v20, v21
    v_pk_fma_f32 v[16:17], v[112:113], v[98:99], v[112:113]
    v_pk_fma_f32 v[16:17], v[114:115], v[18:19], v[16:17]
    v_pk_fma_f32 v[18:19], v[18:19], v[98:99], v[18:19]
    v_exp_f32 v102, v118
    v_exp_f32 v103, v119
    v_pk_fma_f32 v[16:17], v[16:17], v[100:101], v[16:17]
    v_pk_fma_f32 v[16:17], v[116:117], v[18:19], v[16:17]
    v_pk_fma_f32 v[18:19], v[18:19], v[100:101], v[18:19]
    v_exp_f32 v104, v120
    v_exp_f32 v105, v121
    v_pk_fma_f32 v[16:17], v[16:17], v[102:103], v[16:17]
    v_pk_fma_f32 v[16:17], v[118:119], v[18:19], v[16:17]
    v_pk_fma_f32 v[18:19], v[18:19], v[102:103], v[18:19]
    v_exp_f32 v106, v122
    v_exp_f32 v107, v123
    v_pk_fma_f32 v[16:17], v[16:17], v[104:105], v[16:17]
    v_pk_fma_f32 v[16:17], v[120:121], v[18:19], v[16:17]
    v_pk_fma_f32 v[18:19], v[18:19], v[104:105], v[18:19]
    v_exp_f32 v108, v124
    v_exp_f32 v109, v125
    v_pk_fma_f32 v[16:17], v[16:17], v[106:107], v[16:17]
    v_pk_fma_f32 v[16:17], v[122:123], v[18:19], v[16:17]
    v_pk_fma_f32 v[18:19], v[18:19], v[106:107], v[18:19]
    v_exp_f32 v110, v126
    v_exp_f32 v111, v127
    v_pk_fma_f32 v[16:17], v[16:17], v[108:109], v[16:17]
    v_pk_fma_f32 v[16:17], v[124:125], v[18:19], v[16:17]
    v_pk_fma_f32 v[18:19], v[18:19], v[108:109], v[18:19]
    v_pk_fma_f32 v[16:17], v[16:17], v[110:111], v[16:17]
    v_pk_fma_f32 v[16:17], v[126:127], v[18:19], v[16:17]
    v_pk_fma_f32 v[18:19], v[18:19], v[110:111], v[18:19]
SLOTF3:
    s_setprio 0
    s_waitcnt vmcnt(4)
    ds_read_u16_d16_hi v144, v1 offset:4096
    ds_read_u16_d16_hi v145, v1 offset:4352
    ds_read_u16_d16_hi v146, v1 offset:5120
    ds_read_u16_d16_hi v147, v1 offset:5376
    ds_read_u16_d16_hi v148, v1 offset:6144
    ds_read_u16_d16_hi v149, v1 offset:6400
    ds_read_u16_d16_hi v150, v1 offset:7168
    ds_read_u16_d16_hi v151, v1 offset:7424
    ds_read_u16_d16_hi v152, v1 offset:4224
    ds_read_u16_d16_hi v153, v1 offset:4480
    ds_read_u16_d16_hi v154, v1 offset:5248
    ds_read_u16_d16_hi v155, v1 offset:5504
    ds_read_u16_d16_hi v156, v1 offset:6272
    ds_read_u16_d16_hi v157, v1 offset:6528
    ds_read_u16_d16_hi v158, v1 offset:7296
    ds_read_u16_d16_hi v159, v1 offset:7552
    ds_read_u16_d16_hi v160, v1 offset:4160
    ds_read_u16_d16_hi v161, v1 offset:4416
    ds_read_u16_d16_hi v162, v1 offset:5184
    ds_read_u16_d16_hi v163, v1 offset:5440
    ds_read_u16_d16_hi v164, v1 offset:6208
    ds_read_u16_d16_hi v165, v1 offset:6464
    ds_read_u16_d16_hi v166, v1 offset:7232
    ds_read_u16_d16_hi v167, v1 offset:7488
    ds_read_u16_d16_hi v168, v1 offset:4288
    ds_read_u16_d16_hi v169, v1 offset:4544
    ds_read_u16_d16_hi v170, v1 offset:5312
    ds_read_u16_d16_hi v171, v1 offset:5568
    ds_read_u16_d16_hi v172, v1 offset:6336
    ds_read_u16_d16_hi v173, v1 offset:6592
    ds_read_u16_d16_hi v174, v1 offset:7360
    ds_read_u16_d16_hi v175, v1 offset:7616
    ds_read_b64_tr_b16 v[72:73], v11 offset:128
    ds_read_b64_tr_b16 v[74:75], v11 offset:192
    ds_read_u16 v3, v15 offset:80
    ds_read_b32 v26, v4
    ds_read_u16 v10, v5 offset:66
    ds_read_b32 v79, v6 offset:384
    s_mov_b32 m0, s63
    s_cmp_eq_u32 s61, 0
    s_waitcnt lgkmcnt(0)
    s_cbranch_scc1 SKDF3
    buffer_load_dwordx4 v[64:65], s[48:51], s56 idxen offen offset:0 sc1 lds
    buffer_load_dwordx4 v[66:67], s[48:51], s57 idxen offen offset:1024 sc1 lds
    buffer_load_dwordx4 v[68:69], s[48:51], s58 idxen offen offset:2048 sc1 lds
    buffer_load_dwordx4 v[70:71], s[48:51], s59 idxen offen offset:3072 sc1 lds
SKDF3:
    v_exp_f32 v96, v128
    s_setprio 3
    v_mfma_f32_32x32x8_bf16 v[112:127], v[22:23], v[72:73], v[144:159]
    v_exp_f32 v97, v129
    v_rcp_f32 v20, v18
    v_rcp_f32 v21, v19
    v_exp_f32 v98, v130
    v_exp_f32 v99, v131
    v_exp_f32 v100, v132
    v_exp_f32 v101, v133
    v_add_u32 v3, v3, v29
    v_perm_b32 v26, v26, v26, v7
    v_pk_mul_f32 v[20:21], v[16:17], v[20:21]
    v_pk_add_f32 v[18:19], v[96:97], 1.0 op_sel_hi:[1,0]
    v_cvt_pk_bf16_f32 v83, v20, v21
    v_pk_fma_f32 v[16:17], v[128:129], v[98:99], v[128:129]
    v_pk_fma_f32 v[16:17], v[130:131], v[18:19], v[16:17]
    v_pk_fma_f32 v[18:19], v[18:19], v[98:99], v[18:19]
    v_exp_f32 v102, v134
    v_exp_f32 v103, v135
    v_pk_fma_f32 v[16:17], v[16:17], v[100:101], v[16:17]
    v_pk_fma_f32 v[16:17], v[132:133], v[18:19], v[16:17]
    v_pk_fma_f32 v[18:19], v[18:19], v[100:101], v[18:19]
    v_exp_f32 v104, v136
    v_exp_f32 v105, v137
    v_pk_fma_f32 v[16:17], v[16:17], v[102:103], v[16:17]
    v_pk_fma_f32 v[16:17], v[134:135], v[18:19], v[16:17]
    v_pk_fma_f32 v[18:19], v[18:19], v[102:103], v[18:19]
    v_exp_f32 v106, v138
    v_exp_f32 v107, v139
    v_pk_fma_f32 v[16:17], v[16:17], v[104:105], v[16:17]
    v_pk_fma_f32 v[16:17], v[136:137], v[18:19], v[16:17]
    v_pk_fma_f32 v[18:19], v[18:19], v[104:105], v[18:19]
    v_exp_f32 v108, v140
    v_exp_f32 v109, v141
    v_pk_fma_f32 v[16:17], v[16:17], v[106:107], v[16:17]
    v_pk_fma_f32 v[16:17], v[138:139], v[18:19], v[16:17]
    v_pk_fma_f32 v[18:19], v[18:19], v[106:107], v[18:19]
    v_exp_f32 v110, v142
    v_exp_f32 v111, v143
    v_pk_fma_f32 v[16:17], v[16:17], v[108:109], v[16:17]
    v_pk_fma_f32 v[16:17], v[140:141], v[18:19], v[16:17]
    v_pk_fma_f32 v[18:19], v[18:19], v[108:109], v[18:19]
    v_pk_fma_f32 v[16:17], v[16:17], v[110:111], v[16:17]
    v_pk_fma_f32 v[16:17], v[142:143], v[18:19], v[16:17]
    v_pk_fma_f32 v[18:19], v[18:19], v[110:111], v[18:19]
    v_mfma_f32_32x32x8_bf16 v[128:143], v[22:23], v[74:75], v[160:175]
    v_exp_f32 v96, v112
    v_exp_f32 v97, v113
    v_rcp_f32 v20, v18
    v_rcp_f32 v21, v19
    v_exp_f32 v98, v114
    v_exp_f32 v99, v115
    v_exp_f32 v100, v116
    v_exp_f32 v101, v117
    v_mad_u32_u24 v11, v10, v8, v9
    v_add_u32 v15, 64, v15
    v_add_u32 v28, 64, v28
    v_add_u32_e64 v5, 64, v5
    v_add_u32 v6, 512, v6
    v_pk_mul_f32 v[20:21], v[16:17], v[20:21]
    v_pk_add_f32 v[18:19], v[96:97], 1.0 op_sel_hi:[1,0]
    v_cvt_pk_bf16_f32 v87, v20, v21
    v_pk_fma_f32 v[22:23], v[24:25], v[26:27], v[252:253] op_sel_hi:[1,0,1]
    v_pk_fma_f32 v[16:17], v[112:113], v[98:99], v[112:113]
    v_pk_fma_f32 v[16:17], v[114:115], v[18:19], v[16:17]
    v_pk_fma_f32 v[18:19], v[18:19], v[98:99], v[18:19]
    v_exp_f32 v102, v118
    v_exp_f32 v103, v119
    v_pk_fma_f32 v[16:17], v[16:17], v[100:101], v[16:17]
    v_pk_fma_f32 v[16:17], v[116:117], v[18:19], v[16:17]
    v_pk_fma_f32 v[18:19], v[18:19], v[100:101], v[18:19]
    v_exp_f32 v104, v120
    v_exp_f32 v105, v121
    v_pk_fma_f32 v[16:17], v[16:17], v[102:103], v[16:17]
    v_pk_fma_f32 v[16:17], v[118:119], v[18:19], v[16:17]
    v_pk_fma_f32 v[18:19], v[18:19], v[102:103], v[18:19]
    v_exp_f32 v106, v122
    v_exp_f32 v107, v123
    v_pk_fma_f32 v[16:17], v[16:17], v[104:105], v[16:17]
    v_pk_fma_f32 v[16:17], v[120:121], v[18:19], v[16:17]
    v_pk_fma_f32 v[18:19], v[18:19], v[104:105], v[18:19]
    v_exp_f32 v108, v124
    v_exp_f32 v109, v125
    v_pk_fma_f32 v[16:17], v[16:17], v[106:107], v[16:17]
    v_pk_fma_f32 v[16:17], v[122:123], v[18:19], v[16:17]
    v_pk_fma_f32 v[18:19], v[18:19], v[106:107], v[18:19]
    v_exp_f32 v110, v126
    v_exp_f32 v111, v127
    v_pk_fma_f32 v[16:17], v[16:17], v[108:109], v[16:17]
    v_pk_fma_f32 v[16:17], v[124:125], v[18:19], v[16:17]
    v_pk_fma_f32 v[18:19], v[18:19], v[108:109], v[18:19]
    v_pk_fma_f32 v[16:17], v[16:17], v[110:111], v[16:17]
    v_pk_fma_f32 v[16:17], v[126:127], v[18:19], v[16:17]
    v_pk_fma_f32 v[18:19], v[18:19], v[110:111], v[18:19]
    s_sub_u32 s61, s61, 1
    s_cbranch_scc1 TAILF3
    s_setprio 0
    s_waitcnt vmcnt(4)
    ds_read_u16_d16_hi v144, v1 offset:0
    ds_read_u16_d16_hi v145, v1 offset:256
    ds_read_u16_d16_hi v146, v1 offset:1024
    ds_read_u16_d16_hi v147, v1 offset:1280
    ds_read_u16_d16_hi v148, v1 offset:2048
    ds_read_u16_d16_hi v149, v1 offset:2304
    ds_read_u16_d16_hi v150, v1 offset:3072
    ds_read_u16_d16_hi v151, v1 offset:3328
    ds_read_u16_d16_hi v152, v1 offset:128
    ds_read_u16_d16_hi v153, v1 offset:384
    ds_read_u16_d16_hi v154, v1 offset:1152
    ds_read_u16_d16_hi v155, v1 offset:1408
    ds_read_u16_d16_hi v156, v1 offset:2176
    ds_read_u16_d16_hi v157, v1 offset:2432
    ds_read_u16_d16_hi v158, v1 offset:3200
    ds_read_u16_d16_hi v159, v1 offset:3456
    ds_read_u16_d16_hi v160, v1 offset:64
    ds_read_u16_d16_hi v161, v1 offset:320
    ds_read_u16_d16_hi v162, v1 offset:1088
    ds_read_u16_d16_hi v163, v1 offset:1344
    ds_read_u16_d16_hi v164, v1 offset:2112
    ds_read_u16_d16_hi v165, v1 offset:2368
    ds_read_u16_d16_hi v166, v1 offset:3136
    ds_read_u16_d16_hi v167, v1 offset:3392
    ds_read_u16_d16_hi v168, v1 offset:192
    ds_read_u16_d16_hi v169, v1 offset:448
    ds_read_u16_d16_hi v170, v1 offset:1216
    ds_read_u16_d16_hi v171, v1 offset:1472
    ds_read_u16_d16_hi v172, v1 offset:2240
    ds_read_u16_d16_hi v173, v1 offset:2496
    ds_read_u16_d16_hi v174, v1 offset:3264
    ds_read_u16_d16_hi v175, v1 offset:3520
    ds_read_b64_tr_b16 v[72:73], v11 offset:0
    ds_read_b64_tr_b16 v[74:75], v11 offset:64
    ds_read_u16 v64, v3 offset:0
    ds_read_u16 v66, v3 offset:4
    ds_read_u16 v68, v3 offset:8
    ds_read_u16 v70, v3 offset:12
    ds_read_u16 v4, v28 offset:16
    s_mov_b32 m0, s62
    s_waitcnt lgkmcnt(0)
    buffer_load_dwordx4 v[64:65], s[48:51], s52 idxen offen offset:0 sc1 lds
    buffer_load_dwordx4 v[66:67], s[48:51], s53 idxen offen offset:1024 sc1 lds
    buffer_load_dwordx4 v[68:69], s[48:51], s54 idxen offen offset:2048 sc1 lds
    buffer_load_dwordx4 v[70:71], s[48:51], s55 idxen offen offset:3072 sc1 lds
    v_exp_f32 v96, v128
    v_exp_f32 v97, v129
    v_mfma_f32_32x32x16_bf16 v[176:191], v[80:83], v[76:79], v[176:191]
    s_setprio 3
    v_rcp_f32 v20, v18
    v_rcp_f32 v21, v19
    v_exp_f32 v98, v130
    v_mfma_f32_32x32x8_bf16 v[112:127], v[22:23], v[72:73], v[144:159]
    v_exp_f32 v99, v131
    v_exp_f32 v100, v132
    v_exp_f32 v101, v133
    v_exp_f32 v102, v134
    v_exp_f32 v103, v135
    v_exp_f32 v104, v136
    v_exp_f32_e64 v105, v137
    v_pk_mul_f32 v[20:21], v[16:17], v[20:21]
    v_pk_add_f32 v[18:19], v[96:97], 1.0 op_sel_hi:[1,0]
    v_cvt_pk_bf16_f32 v91, v20, v21
    v_pk_fma_f32 v[16:17], v[128:129], v[98:99], v[128:129]
    v_pk_fma_f32 v[16:17], v[130:131], v[18:19], v[16:17]
    v_pk_fma_f32 v[18:19], v[18:19], v[98:99], v[18:19]
    v_pk_fma_f32 v[16:17], v[16:17], v[100:101], v[16:17]
    v_pk_fma_f32 v[16:17], v[132:133], v[18:19], v[16:17]
    v_pk_fma_f32 v[18:19], v[18:19], v[100:101], v[18:19]
    v_pk_fma_f32 v[16:17], v[16:17], v[102:103], v[16:17]
    v_pk_fma_f32 v[16:17], v[134:135], v[18:19], v[16:17]
    v_pk_fma_f32 v[18:19], v[18:19], v[102:103], v[18:19]
    v_exp_f32 v106, v138
    v_exp_f32 v107, v139
    v_pk_fma_f32 v[16:17], v[16:17], v[104:105], v[16:17]
    v_pk_fma_f32 v[16:17], v[136:137], v[18:19], v[16:17]
    v_pk_fma_f32 v[18:19], v[18:19], v[104:105], v[18:19]
    v_exp_f32 v108, v140
    v_exp_f32 v109, v141
    v_pk_fma_f32 v[16:17], v[16:17], v[106:107], v[16:17]
    v_pk_fma_f32 v[16:17], v[138:139], v[18:19], v[16:17]
    v_pk_fma_f32 v[18:19], v[18:19], v[106:107], v[18:19]
    v_exp_f32 v110, v142
    v_exp_f32 v111, v143
    v_pk_fma_f32 v[16:17], v[16:17], v[108:109], v[16:17]
    v_pk_fma_f32 v[16:17], v[140:141], v[18:19], v[16:17]
    v_pk_fma_f32 v[18:19], v[18:19], v[108:109], v[18:19]
    v_pk_fma_f32 v[16:17], v[16:17], v[110:111], v[16:17]
    v_pk_fma_f32 v[16:17], v[142:143], v[18:19], v[16:17]
    v_pk_fma_f32 v[18:19], v[18:19], v[110:111], v[18:19]
    v_mfma_f32_32x32x8_bf16 v[128:143], v[22:23], v[74:75], v[160:175]
    v_exp_f32 v96, v112
    v_exp_f32 v97, v113
    v_rcp_f32 v20, v18
    v_rcp_f32 v21, v19
    v_exp_f32 v98, v114
    v_exp_f32 v99, v115
    v_exp_f32 v100, v116
    v_exp_f32 v101, v117
    v_add_u32_e64 v4, v4, v30
    v_pk_mul_f32 v[20:21], v[16:17], v[20:21]
    v_pk_add_f32 v[18:19], v[96:97], 1.0 op_sel_hi:[1,0]
    v_cvt_pk_bf16_f32 v95, v20, v21
    v_pk_fma_f32 v[16:17], v[112:113], v[98:99], v[112:113]
    v_pk_fma_f32 v[16:17], v[114:115], v[18:19], v[16:17]
    v_pk_fma_f32 v[18:19], v[18:19], v[98:99], v[18:19]
    v_exp_f32 v102, v118
    v_exp_f32 v103, v119
    v_pk_fma_f32 v[16:17], v[16:17], v[100:101], v[16:17]
    v_pk_fma_f32 v[16:17], v[116:117], v[18:19], v[16:17]
    v_pk_fma_f32 v[18:19], v[18:19], v[100:101], v[18:19]
    v_exp_f32 v104, v120
    v_exp_f32 v105, v121
    v_pk_fma_f32 v[16:17], v[16:17], v[102:103], v[16:17]
    v_pk_fma_f32 v[16:17], v[118:119], v[18:19], v[16:17]
    v_pk_fma_f32 v[18:19], v[18:19], v[102:103], v[18:19]
    v_exp_f32 v106, v122
    v_exp_f32 v107, v123
    v_pk_fma_f32 v[16:17], v[16:17], v[104:105], v[16:17]
    v_pk_fma_f32 v[16:17], v[120:121], v[18:19], v[16:17]
    v_pk_fma_f32 v[18:19], v[18:19], v[104:105], v[18:19]
    v_exp_f32 v108, v124
    v_exp_f32 v109, v125
    v_pk_fma_f32 v[16:17], v[16:17], v[106:107], v[16:17]
    v_pk_fma_f32 v[16:17], v[122:123], v[18:19], v[16:17]
    v_pk_fma_f32 v[18:19], v[18:19], v[106:107], v[18:19]
    v_exp_f32 v110, v126
    v_exp_f32 v111, v127
    v_pk_fma_f32 v[16:17], v[16:17], v[108:109], v[16:17]
    v_pk_fma_f32 v[16:17], v[124:125], v[18:19], v[16:17]
    v_pk_fma_f32 v[18:19], v[18:19], v[108:109], v[18:19]
    v_pk_fma_f32 v[16:17], v[16:17], v[110:111], v[16:17]
    v_pk_fma_f32 v[16:17], v[126:127], v[18:19], v[16:17]
    v_pk_fma_f32 v[18:19], v[18:19], v[110:111], v[18:19]
    s_branch LOOPF
    s_nop 0
TAILF2:
    s_setprio 0
    s_nop 0
    ds_read_b64_tr_b16 v[32:33], v246 offset:0
    ds_read_b64_tr_b16 v[34:35], v246 offset:1024
    ds_read_b64_tr_b16 v[36:37], v246 offset:32
    ds_read_b64_tr_b16 v[38:39], v246 offset:1056
    ds_read_b64_tr_b16 v[40:41], v27 offset:0
    ds_read_b64_tr_b16 v[42:43], v27 offset:1024
    ds_read_b64_tr_b16 v[44:45], v27 offset:32
    ds_read_b64_tr_b16 v[46:47], v27 offset:1056
    ds_read_b64_tr_b16 v[48:49], v246 offset:4096
    ds_read_b64_tr_b16 v[50:51], v246 offset:5120
    ds_read_b64_tr_b16 v[52:53], v246 offset:4128
    ds_read_b64_tr_b16 v[54:55], v246 offset:5152
    ds_read_b64_tr_b16 v[56:57], v27 offset:4096
    ds_read_b64_tr_b16 v[58:59], v27 offset:5120
    ds_read_b64_tr_b16 v[60:61], v27 offset:4128
    ds_read_b64_tr_b16 v[62:63], v27 offset:5152
    ds_read_b64_tr_b16 v[144:145], v246 offset:8192
    ds_read_b64_tr_b16 v[146:147], v246 offset:9216
    ds_read_b64_tr_b16 v[148:149], v246 offset:8224
    ds_read_b64_tr_b16 v[150:151], v246 offset:9248
    ds_read_b64_tr_b16 v[152:153], v27 offset:8192
    ds_read_b64_tr_b16 v[154:155], v27 offset:9216
    ds_read_b64_tr_b16 v[156:157], v27 offset:8224
    ds_read_b64_tr_b16 v[158:159], v27 offset:9248
    ds_read_b64_tr_b16 v[160:161], v246 offset:12288
    ds_read_b64_tr_b16 v[162:163], v246 offset:13312
    ds_read_b64_tr_b16 v[164:165], v246 offset:12320
    ds_read_b64_tr_b16 v[166:167], v246 offset:13344
    ds_read_b64_tr_b16 v[168:169], v27 offset:12288
    ds_read_b64_tr_b16 v[170:171], v27 offset:13312
    ds_read_b64_tr_b16 v[172:173], v27 offset:12320
    ds_read_b64_tr_b16 v[174:175], v27 offset:13344
    v_exp_f32 v96, v128
    s_setprio 3
    v_exp_f32 v97, v129
    v_rcp_f32 v20, v18
    v_rcp_f32 v21, v19
    v_exp_f32 v98, v130
    v_exp_f32 v99, v131
    v_exp_f32 v100, v132
    v_exp_f32_e64 v101, v133
    v_pk_mul_f32 v[20:21], v[16:17], v[20:21]
    v_pk_add_f32 v[18:19], v[96:97], 1.0 op_sel_hi:[1,0]
    v_cvt_pk_bf16_f32 v90, v20, v21
    v_pk_fma_f32 v[16:17], v[128:129], v[98:99], v[128:129]
    v_pk_fma_f32 v[16:17], v[130:131], v[18:19], v[16:17]
    v_pk_fma_f32 v[18:19], v[18:19], v[98:99], v[18:19]
    v_exp_f32 v102, v134
    v_exp_f32 v103, v135
    v_pk_fma_f32 v[16:17], v[16:17], v[100:101], v[16:17]
    v_pk_fma_f32 v[16:17], v[132:133], v[18:19], v[16:17]
    v_pk_fma_f32 v[18:19], v[18:19], v[100:101], v[18:19]
    v_exp_f32 v104, v136
    v_exp_f32 v105, v137
    v_pk_fma_f32 v[16:17], v[16:17], v[102:103], v[16:17]
    v_pk_fma_f32 v[16:17], v[134:135], v[18:19], v[16:17]
    v_pk_fma_f32 v[18:19], v[18:19], v[102:103], v[18:19]
    v_exp_f32 v106, v138
    v_exp_f32 v107, v139
    v_pk_fma_f32 v[16:17], v[16:17], v[104:105], v[16:17]
    v_pk_fma_f32 v[16:17], v[136:137], v[18:19], v[16:17]
    v_pk_fma_f32 v[18:19], v[18:19], v[104:105], v[18:19]
    v_exp_f32 v108, v140
    v_exp_f32 v109, v141
    v_pk_fma_f32 v[16:17], v[16:17], v[106:107], v[16:17]
    v_pk_fma_f32 v[16:17], v[138:139], v[18:19], v[16:17]
    v_pk_fma_f32 v[18:19], v[18:19], v[106:107], v[18:19]
    v_exp_f32 v110, v142
    v_exp_f32 v111, v143
    v_pk_fma_f32 v[16:17], v[16:17], v[108:109], v[16:17]
    v_pk_fma_f32 v[16:17], v[140:141], v[18:19], v[16:17]
    v_pk_fma_f32 v[18:19], v[18:19], v[108:109], v[18:19]
    v_pk_fma_f32 v[16:17], v[16:17], v[110:111], v[16:17]
    v_pk_fma_f32 v[16:17], v[142:143], v[18:19], v[16:17]
    v_pk_fma_f32 v[18:19], v[18:19], v[110:111], v[18:19]
    v_rcp_f32 v20, v18
    v_rcp_f32 v21, v19
    v_mov_b32_e64 v79, 0
    v_pk_mul_f32 v[20:21], v[16:17], v[20:21]
    v_cvt_pk_bf16_f32 v94, v20, v21
    s_nop 0
    s_branch DRAIN
TAILF3:
    s_setprio 0
    s_nop 0
    ds_read_b64_tr_b16 v[32:33], v246 offset:0
    ds_read_b64_tr_b16 v[34:35], v246 offset:1024
    ds_read_b64_tr_b16 v[36:37], v246 offset:32
    ds_read_b64_tr_b16 v[38:39], v246 offset:1056
    ds_read_b64_tr_b16 v[40:41], v27 offset:0
    ds_read_b64_tr_b16 v[42:43], v27 offset:1024
    ds_read_b64_tr_b16 v[44:45], v27 offset:32
    ds_read_b64_tr_b16 v[46:47], v27 offset:1056
    ds_read_b64_tr_b16 v[48:49], v246 offset:4096
    ds_read_b64_tr_b16 v[50:51], v246 offset:5120
    ds_read_b64_tr_b16 v[52:53], v246 offset:4128
    ds_read_b64_tr_b16 v[54:55], v246 offset:5152
    ds_read_b64_tr_b16 v[56:57], v27 offset:4096
    ds_read_b64_tr_b16 v[58:59], v27 offset:5120
    ds_read_b64_tr_b16 v[60:61], v27 offset:4128
    ds_read_b64_tr_b16 v[62:63], v27 offset:5152
    ds_read_b64_tr_b16 v[144:145], v246 offset:8192
    ds_read_b64_tr_b16 v[146:147], v246 offset:9216
    ds_read_b64_tr_b16 v[148:149], v246 offset:8224
    ds_read_b64_tr_b16 v[150:151], v246 offset:9248
    ds_read_b64_tr_b16 v[152:153], v27 offset:8192
    ds_read_b64_tr_b16 v[154:155], v27 offset:9216
    ds_read_b64_tr_b16 v[156:157], v27 offset:8224
    ds_read_b64_tr_b16 v[158:159], v27 offset:9248
    ds_read_b64_tr_b16 v[160:161], v246 offset:12288
    ds_read_b64_tr_b16 v[162:163], v246 offset:13312
    ds_read_b64_tr_b16 v[164:165], v246 offset:12320
    ds_read_b64_tr_b16 v[166:167], v246 offset:13344
    ds_read_b64_tr_b16 v[168:169], v27 offset:12288
    ds_read_b64_tr_b16 v[170:171], v27 offset:13312
    ds_read_b64_tr_b16 v[172:173], v27 offset:12320
    ds_read_b64_tr_b16 v[174:175], v27 offset:13344
    v_exp_f32 v96, v128
    s_setprio 3
    v_exp_f32 v97, v129
    v_rcp_f32 v20, v18
    v_rcp_f32 v21, v19
    v_exp_f32 v98, v130
    v_exp_f32 v99, v131
    v_exp_f32 v100, v132
    v_exp_f32_e64 v101, v133
    v_pk_mul_f32 v[20:21], v[16:17], v[20:21]
    v_pk_add_f32 v[18:19], v[96:97], 1.0 op_sel_hi:[1,0]
    v_cvt_pk_bf16_f32 v91, v20, v21
    v_pk_fma_f32 v[16:17], v[128:129], v[98:99], v[128:129]
    v_pk_fma_f32 v[16:17], v[130:131], v[18:19], v[16:17]
    v_pk_fma_f32 v[18:19], v[18:19], v[98:99], v[18:19]
    v_exp_f32 v102, v134
    v_exp_f32 v103, v135
    v_pk_fma_f32 v[16:17], v[16:17], v[100:101], v[16:17]
    v_pk_fma_f32 v[16:17], v[132:133], v[18:19], v[16:17]
    v_pk_fma_f32 v[18:19], v[18:19], v[100:101], v[18:19]
    v_exp_f32 v104, v136
    v_exp_f32 v105, v137
    v_pk_fma_f32 v[16:17], v[16:17], v[102:103], v[16:17]
    v_pk_fma_f32 v[16:17], v[134:135], v[18:19], v[16:17]
    v_pk_fma_f32 v[18:19], v[18:19], v[102:103], v[18:19]
    v_exp_f32 v106, v138
    v_exp_f32 v107, v139
    v_pk_fma_f32 v[16:17], v[16:17], v[104:105], v[16:17]
    v_pk_fma_f32 v[16:17], v[136:137], v[18:19], v[16:17]
    v_pk_fma_f32 v[18:19], v[18:19], v[104:105], v[18:19]
    v_exp_f32 v108, v140
    v_exp_f32 v109, v141
    v_pk_fma_f32 v[16:17], v[16:17], v[106:107], v[16:17]
    v_pk_fma_f32 v[16:17], v[138:139], v[18:19], v[16:17]
    v_pk_fma_f32 v[18:19], v[18:19], v[106:107], v[18:19]
    v_exp_f32 v110, v142
    v_exp_f32 v111, v143
    v_pk_fma_f32 v[16:17], v[16:17], v[108:109], v[16:17]
    v_pk_fma_f32 v[16:17], v[140:141], v[18:19], v[16:17]
    v_pk_fma_f32 v[18:19], v[18:19], v[108:109], v[18:19]
    v_pk_fma_f32 v[16:17], v[16:17], v[110:111], v[16:17]
    v_pk_fma_f32 v[16:17], v[142:143], v[18:19], v[16:17]
    v_pk_fma_f32 v[18:19], v[18:19], v[110:111], v[18:19]
    v_rcp_f32 v20, v18
    v_rcp_f32 v21, v19
    v_mov_b32_e64 v31, 0
    v_pk_mul_f32 v[20:21], v[16:17], v[20:21]
    v_cvt_pk_bf16_f32 v95, v20, v21
    s_nop 0
    s_branch DRAIN
TAILF0:
    s_setprio 0
    s_nop 0
    ds_read_b64_tr_b16 v[32:33], v246 offset:0
    ds_read_b64_tr_b16 v[34:35], v246 offset:1024
    ds_read_b64_tr_b16 v[36:37], v246 offset:32
    ds_read_b64_tr_b16 v[38:39], v246 offset:1056
    ds_read_b64_tr_b16 v[40:41], v27 offset:0
    ds_read_b64_tr_b16 v[42:43], v27 offset:1024
    ds_read_b64_tr_b16 v[44:45], v27 offset:32
    ds_read_b64_tr_b16 v[46:47], v27 offset:1056
    ds_read_b64_tr_b16 v[48:49], v246 offset:4096
    ds_read_b64_tr_b16 v[50:51], v246 offset:5120
    ds_read_b64_tr_b16 v[52:53], v246 offset:4128
    ds_read_b64_tr_b16 v[54:55], v246 offset:5152
    ds_read_b64_tr_b16 v[56:57], v27 offset:4096
    ds_read_b64_tr_b16 v[58:59], v27 offset:5120
    ds_read_b64_tr_b16 v[60:61], v27 offset:4128
    ds_read_b64_tr_b16 v[62:63], v27 offset:5152
    ds_read_b64_tr_b16 v[144:145], v246 offset:8192
    ds_read_b64_tr_b16 v[146:147], v246 offset:9216
    ds_read_b64_tr_b16 v[148:149], v246 offset:8224
    ds_read_b64_tr_b16 v[150:151], v246 offset:9248
    ds_read_b64_tr_b16 v[152:153], v27 offset:8192
    ds_read_b64_tr_b16 v[154:155], v27 offset:9216
    ds_read_b64_tr_b16 v[156:157], v27 offset:8224
    ds_read_b64_tr_b16 v[158:159], v27 offset:9248
    ds_read_b64_tr_b16 v[160:161], v246 offset:12288
    ds_read_b64_tr_b16 v[162:163], v246 offset:13312
    ds_read_b64_tr_b16 v[164:165], v246 offset:12320
    ds_read_b64_tr_b16 v[166:167], v246 offset:13344
    ds_read_b64_tr_b16 v[168:169], v27 offset:12288
    ds_read_b64_tr_b16 v[170:171], v27 offset:13312
    ds_read_b64_tr_b16 v[172:173], v27 offset:12320
    ds_read_b64_tr_b16 v[174:175], v27 offset:13344
    v_exp_f32 v96, v128
    v_exp_f32 v97, v129
    v_mfma_f32_32x32x16_bf16 v[224:239], v[92:95], v[76:79], v[224:239]
    s_setprio 3
    v_rcp_f32 v20, v18
    v_rcp_f32 v21, v19
    v_exp_f32 v98, v130
    v_exp_f32 v99, v131
    v_exp_f32 v100, v132
    v_exp_f32_e64 v101, v133
    v_pk_mul_f32 v[20:21], v[16:17], v[20:21]
    v_pk_add_f32 v[18:19], v[96:97], 1.0 op_sel_hi:[1,0]
    v_cvt_pk_bf16_f32 v88, v20, v21
    v_pk_fma_f32 v[16:17], v[128:129], v[98:99], v[128:129]
    v_pk_fma_f32 v[16:17], v[130:131], v[18:19], v[16:17]
    v_pk_fma_f32 v[18:19], v[18:19], v[98:99], v[18:19]
    v_exp_f32 v102, v134
    v_exp_f32 v103, v135
    v_pk_fma_f32 v[16:17], v[16:17], v[100:101], v[16:17]
    v_pk_fma_f32 v[16:17], v[132:133], v[18:19], v[16:17]
    v_pk_fma_f32 v[18:19], v[18:19], v[100:101], v[18:19]
    v_exp_f32 v104, v136
    v_exp_f32 v105, v137
    v_pk_fma_f32 v[16:17], v[16:17], v[102:103], v[16:17]
    v_pk_fma_f32 v[16:17], v[134:135], v[18:19], v[16:17]
    v_pk_fma_f32 v[18:19], v[18:19], v[102:103], v[18:19]
    v_exp_f32 v106, v138
    v_exp_f32 v107, v139
    v_pk_fma_f32 v[16:17], v[16:17], v[104:105], v[16:17]
    v_pk_fma_f32 v[16:17], v[136:137], v[18:19], v[16:17]
    v_pk_fma_f32 v[18:19], v[18:19], v[104:105], v[18:19]
    v_exp_f32 v108, v140
    v_exp_f32 v109, v141
    v_pk_fma_f32 v[16:17], v[16:17], v[106:107], v[16:17]
    v_pk_fma_f32 v[16:17], v[138:139], v[18:19], v[16:17]
    v_pk_fma_f32 v[18:19], v[18:19], v[106:107], v[18:19]
    v_exp_f32 v110, v142
    v_exp_f32 v111, v143
    v_pk_fma_f32 v[16:17], v[16:17], v[108:109], v[16:17]
    v_pk_fma_f32 v[16:17], v[140:141], v[18:19], v[16:17]
    v_pk_fma_f32 v[18:19], v[18:19], v[108:109], v[18:19]
    v_pk_fma_f32 v[16:17], v[16:17], v[110:111], v[16:17]
    v_pk_fma_f32 v[16:17], v[142:143], v[18:19], v[16:17]
    v_pk_fma_f32 v[18:19], v[18:19], v[110:111], v[18:19]
    ds_read_b32 v76, v6
    v_rcp_f32 v20, v18
    v_rcp_f32 v21, v19
    v_mov_b32_e64 v77, 0
    v_mov_b32_e64 v78, 0
    v_mov_b32_e64 v79, 0
    v_pk_mul_f32 v[20:21], v[16:17], v[20:21]
    v_cvt_pk_bf16_f32 v92, v20, v21
    s_nop 0
    s_branch DRAIN
TAILF1:
    s_setprio 0
    s_nop 0
    ds_read_b64_tr_b16 v[32:33], v246 offset:0
    ds_read_b64_tr_b16 v[34:35], v246 offset:1024
    ds_read_b64_tr_b16 v[36:37], v246 offset:32
    ds_read_b64_tr_b16 v[38:39], v246 offset:1056
    ds_read_b64_tr_b16 v[40:41], v27 offset:0
    ds_read_b64_tr_b16 v[42:43], v27 offset:1024
    ds_read_b64_tr_b16 v[44:45], v27 offset:32
    ds_read_b64_tr_b16 v[46:47], v27 offset:1056
    ds_read_b64_tr_b16 v[48:49], v246 offset:4096
    ds_read_b64_tr_b16 v[50:51], v246 offset:5120
    ds_read_b64_tr_b16 v[52:53], v246 offset:4128
    ds_read_b64_tr_b16 v[54:55], v246 offset:5152
    ds_read_b64_tr_b16 v[56:57], v27 offset:4096
    ds_read_b64_tr_b16 v[58:59], v27 offset:5120
    ds_read_b64_tr_b16 v[60:61], v27 offset:4128
    ds_read_b64_tr_b16 v[62:63], v27 offset:5152
    ds_read_b64_tr_b16 v[144:145], v246 offset:8192
    ds_read_b64_tr_b16 v[146:147], v246 offset:9216
    ds_read_b64_tr_b16 v[148:149], v246 offset:8224
    ds_read_b64_tr_b16 v[150:151], v246 offset:9248
    ds_read_b64_tr_b16 v[152:153], v27 offset:8192
    ds_read_b64_tr_b16 v[154:155], v27 offset:9216
    ds_read_b64_tr_b16 v[156:157], v27 offset:8224
    ds_read_b64_tr_b16 v[158:159], v27 offset:9248
    ds_read_b64_tr_b16 v[160:161], v246 offset:12288
    ds_read_b64_tr_b16 v[162:163], v246 offset:13312
    ds_read_b64_tr_b16 v[164:165], v246 offset:12320
    ds_read_b64_tr_b16 v[166:167], v246 offset:13344
    ds_read_b64_tr_b16 v[168:169], v27 offset:12288
    ds_read_b64_tr_b16 v[170:171], v27 offset:13312
    ds_read_b64_tr_b16 v[172:173], v27 offset:12320
    ds_read_b64_tr_b16 v[174:175], v27 offset:13344
    v_exp_f32 v96, v128
    s_setprio 3
    v_exp_f32 v97, v129
    v_rcp_f32 v20, v18
    v_rcp_f32 v21, v19
    v_exp_f32 v98, v130
    v_exp_f32 v99, v131
    v_exp_f32 v100, v132
    v_exp_f32_e64 v101, v133
    v_pk_mul_f32 v[20:21], v[16:17], v[20:21]
    v_pk_add_f32 v[18:19], v[96:97], 1.0 op_sel_hi:[1,0]
    v_cvt_pk_bf16_f32 v89, v20, v21
    v_pk_fma_f32 v[16:17], v[128:129], v[98:99], v[128:129]
    v_pk_fma_f32 v[16:17], v[130:131], v[18:19], v[16:17]
    v_pk_fma_f32 v[18:19], v[18:19], v[98:99], v[18:19]
    v_exp_f32 v102, v134
    v_exp_f32 v103, v135
    v_pk_fma_f32 v[16:17], v[16:17], v[100:101], v[16:17]
    v_pk_fma_f32 v[16:17], v[132:133], v[18:19], v[16:17]
    v_pk_fma_f32 v[18:19], v[18:19], v[100:101], v[18:19]
    v_exp_f32 v104, v136
    v_exp_f32 v105, v137
    v_pk_fma_f32 v[16:17], v[16:17], v[102:103], v[16:17]
    v_pk_fma_f32 v[16:17], v[134:135], v[18:19], v[16:17]
    v_pk_fma_f32 v[18:19], v[18:19], v[102:103], v[18:19]
    v_exp_f32 v106, v138
    v_exp_f32 v107, v139
    v_pk_fma_f32 v[16:17], v[16:17], v[104:105], v[16:17]
    v_pk_fma_f32 v[16:17], v[136:137], v[18:19], v[16:17]
    v_pk_fma_f32 v[18:19], v[18:19], v[104:105], v[18:19]
    v_exp_f32 v108, v140
    v_exp_f32 v109, v141
    v_pk_fma_f32 v[16:17], v[16:17], v[106:107], v[16:17]
    v_pk_fma_f32 v[16:17], v[138:139], v[18:19], v[16:17]
    v_pk_fma_f32 v[18:19], v[18:19], v[106:107], v[18:19]
    v_exp_f32 v110, v142
    v_exp_f32 v111, v143
    v_pk_fma_f32 v[16:17], v[16:17], v[108:109], v[16:17]
    v_pk_fma_f32 v[16:17], v[140:141], v[18:19], v[16:17]
    v_pk_fma_f32 v[18:19], v[18:19], v[108:109], v[18:19]
    v_pk_fma_f32 v[16:17], v[16:17], v[110:111], v[16:17]
    v_pk_fma_f32 v[16:17], v[142:143], v[18:19], v[16:17]
    v_pk_fma_f32 v[18:19], v[18:19], v[110:111], v[18:19]
    v_rcp_f32 v20, v18
    v_rcp_f32 v21, v19
    v_mov_b32_e64 v78, 0
    v_mov_b32_e64 v79, 0
    v_pk_mul_f32 v[20:21], v[16:17], v[20:21]
    v_cvt_pk_bf16_f32 v93, v20, v21
    s_nop 0
    s_nop 0
DRAIN:
    s_waitcnt lgkmcnt(0)
    s_cmp_lg_u32 s66, 0
    v_mfma_f32_32x32x16_bf16 v[176:191], v[80:83], v[76:79], v[176:191]
    v_mfma_f32_32x32x16_bf16 v[192:207], v[84:87], v[76:79], v[192:207]
    v_mfma_f32_32x32x16_bf16 v[208:223], v[88:91], v[76:79], v[208:223]
    v_mfma_f32_32x32x16_bf16 v[224:239], v[92:95], v[76:79], v[224:239]
    s_cbranch_scc1 NEXTR
    v_lshrrev_b32 v96, 4, v14
    v_mul_u32_u24 v97, 272, v245
    v_lshl_add_u32 v97, v96, 4, v97
    v_add_u32 v97, s62, v97
    v_lshrrev_b32 v98, 3, v13
    v_and_b32 v99, 7, v13
    s_mov_b32 s6, 0xffff0000
    s_mov_b32 s7, s6
    v_cvt_pk_bf16_f32 v64, v176, v177
    v_cvt_pk_bf16_f32 v65, v178, v179
    v_cvt_pk_bf16_f32 v66, v180, v181
    v_cvt_pk_bf16_f32 v67, v182, v183
    s_mov_b64 exec, s[6:7]
    v_cvt_pk_bf16_f32 v64, v184, v185
    v_cvt_pk_bf16_f32 v65, v186, v187
    v_cvt_pk_bf16_f32 v66, v188, v189
    v_cvt_pk_bf16_f32 v67, v190, v191
    s_mov_b64 exec, -1
    v_cvt_pk_bf16_f32 v68, v192, v193
    v_cvt_pk_bf16_f32 v69, v194, v195
    v_cvt_pk_bf16_f32 v70, v196, v197
    v_cvt_pk_bf16_f32 v71, v198, v199
    s_mov_b64 exec, s[6:7]
    v_cvt_pk_bf16_f32 v68, v200, v201
    v_cvt_pk_bf16_f32 v69, v202, v203
    v_cvt_pk_bf16_f32 v70, v204, v205
    v_cvt_pk_bf16_f32 v71, v206, v207
    s_mov_b64 exec, -1
    v_mfma_f32_16x16x32_bf16 v[112:115], v[32:35], v[64:67], 0
    v_mfma_f32_16x16x32_bf16 v[116:119], v[36:39], v[64:67], 0
    v_mfma_f32_16x16x32_bf16 v[120:123], v[40:43], v[64:67], 0
    v_mfma_f32_16x16x32_bf16 v[124:127], v[44:47], v[64:67], 0
    v_cvt_pk_bf16_f32 v72, v208, v209
    v_cvt_pk_bf16_f32 v73, v210, v211
    v_cvt_pk_bf16_f32 v74, v212, v213
    v_cvt_pk_bf16_f32 v75, v214, v215
    s_mov_b64 exec, s[6:7]
    v_cvt_pk_bf16_f32 v72, v216, v217
    v_cvt_pk_bf16_f32 v73, v218, v219
    v_cvt_pk_bf16_f32 v74, v220, v221
    v_cvt_pk_bf16_f32 v75, v222, v223
    s_mov_b64 exec, -1
    v_mfma_f32_16x16x32_bf16 v[112:115], v[48:51], v[68:71], v[112:115]
    v_mul_u32_u24 v100, 43, v98
    v_mfma_f32_16x16x32_bf16 v[116:119], v[52:55], v[68:71], v[116:119]
    v_add_u32 v100, 86, v100
    v_mfma_f32_16x16x32_bf16 v[120:123], v[56:59], v[68:71], v[120:123]
    v_lshrrev_b32 v100, 8, v100
    v_mfma_f32_16x16x32_bf16 v[124:127], v[60:63], v[68:71], v[124:127]
    v_med3_u32 v100, v100, 1, 7
    v_cvt_pk_bf16_f32 v76, v224, v225
    v_cvt_pk_bf16_f32 v77, v226, v227
    v_cvt_pk_bf16_f32 v78, v228, v229
    v_cvt_pk_bf16_f32 v79, v230, v231
    s_mov_b64 exec, s[6:7]
    v_cvt_pk_bf16_f32 v76, v232, v233
    v_cvt_pk_bf16_f32 v77, v234, v235
    v_cvt_pk_bf16_f32 v78, v236, v237
    v_cvt_pk_bf16_f32 v79, v238, v239
    s_mov_b64 exec, -1
    v_mfma_f32_16x16x32_bf16 v[112:115], v[144:147], v[72:75], v[112:115]
    v_mul_u32_u24 v100, 8704, v100
    v_mfma_f32_16x16x32_bf16 v[116:119], v[148:151], v[72:75], v[116:119]
    v_and_b32_e64 v101, 15, v98
    v_mfma_f32_16x16x32_bf16 v[120:123], v[152:155], v[72:75], v[120:123]
    v_mul_u32_u24 v101, 272, v101
    v_mfma_f32_16x16x32_bf16 v[124:127], v[156:159], v[72:75], v[124:127]
    v_lshlrev_b32_e64 v102, 5, v99
    v_mfma_f32_16x16x32_bf16 v[112:115], v[160:163], v[76:79], v[112:115]
    v_add3_u32 v100, v100, v101, v102
    v_mfma_f32_16x16x32_bf16 v[116:119], v[164:167], v[76:79], v[116:119]
    v_subrev_u32 v100, 8704, v100
    v_mfma_f32_16x16x32_bf16 v[120:123], v[168:171], v[76:79], v[120:123]
    v_lshlrev_b32 v101, 2, v98
    v_mfma_f32_16x16x32_bf16 v[124:127], v[172:175], v[76:79], v[124:127]
    v_lshlrev_b32_e64 v103, 15, v98
    v_lshl_add_u32 v103, v99, 4, v103
    s_lshl_b32 s5, s3, 7
    v_add_u32 v103, s5, v103
    s_waitcnt vmcnt(0)
    ds_write_b128 v97, v[112:115] offset:0
    ds_write_b128 v97, v[116:119] offset:64
    ds_write_b128 v97, v[120:123] offset:128
    ds_write_b128 v97, v[124:127] offset:192
    ds_read_b128 v[32:35], v102 offset:2816
    ds_read_b128 v[36:39], v102 offset:2832
    v_cmp_gt_u32 vcc, 49, v98
    s_or_b32 s6, s2, s4
    s_cbranch_scc1 EPI_NE
    v_mov_b32 v42, s73
    v_mov_b32 v43, s72
    v_mov_b32 v44, 0
    s_mov_b64 exec, 1
    buffer_store_dwordx2 v[42:43], v44, s[44:47], 0 offen offset:0
    s_mov_b64 exec, -1
EPI_NE:
    s_waitcnt lgkmcnt(0)
    s_barrier
    s_and_b64 exec, exec, vcc
    s_cbranch_execz K_FIN
    ds_read_b32 v40, v101 offset:2368
    ds_read_b128 v[64:67], v100 offset:4096
    ds_read_b128 v[68:71], v100 offset:4112
    ds_read_b128 v[72:75], v100 offset:12800
    ds_read_b128 v[76:79], v100 offset:12816
    s_mov_b32 s6, 0xbf317218
    s_mov_b32 s7, s6
    s_waitcnt lgkmcnt(4)
    v_cvt_f32_u32_e64 v40, v40
    v_pk_mul_f32 v[32:33], v[32:33], v[40:41] op_sel_hi:[1,0]
    v_pk_mul_f32 v[34:35], v[34:35], v[40:41] op_sel_hi:[1,0]
    v_pk_mul_f32 v[36:37], v[36:37], v[40:41] op_sel_hi:[1,0]
    v_pk_mul_f32 v[38:39], v[38:39], v[40:41] op_sel_hi:[1,0]
    s_waitcnt lgkmcnt(2)
    v_pk_fma_f32 v[32:33], v[64:65], s[6:7], v[32:33]
    v_pk_fma_f32 v[34:35], v[66:67], s[6:7], v[34:35]
    v_pk_fma_f32 v[36:37], v[68:69], s[6:7], v[36:37]
    v_pk_fma_f32 v[38:39], v[70:71], s[6:7], v[38:39]
    s_waitcnt lgkmcnt(0)
    v_pk_fma_f32 v[32:33], v[72:73], s[6:7], v[32:33]
    v_pk_fma_f32 v[34:35], v[74:75], s[6:7], v[34:35]
    v_pk_fma_f32 v[36:37], v[76:77], s[6:7], v[36:37]
    v_pk_fma_f32 v[38:39], v[78:79], s[6:7], v[38:39]
    v_cvt_pk_bf16_f32 v44, v32, v33
    v_cvt_pk_bf16_f32 v45, v34, v35
    v_cvt_pk_bf16_f32 v46, v36, v37
    v_cvt_pk_bf16_f32 v47, v38, v39
    buffer_store_dwordx4 v[44:47], v103, s[40:43], 0 offen
K_FIN:
K_END:
    s_endpgm
R_THIRD:
    v_mov_b32_dpp v128, v34 quad_perm:[0,0,0,0] row_mask:0xf bank_mask:0xf
    v_mov_b32_dpp v129, v34 quad_perm:[1,1,1,1] row_mask:0xf bank_mask:0xf
    v_mov_b32_dpp v130, v34 quad_perm:[2,2,2,2] row_mask:0xf bank_mask:0xf
    v_mov_b32_dpp v131, v34 quad_perm:[3,3,3,3] row_mask:0xf bank_mask:0xf
    v_sub_u32 v128, v128, v37
    v_sub_u32 v129, v129, v37
    v_sub_u32 v130, v130, v37
    v_sub_u32 v131, v131, v37
    v_cmp_lt_i32 vcc, 32, v128
    s_mov_b64 exec, vcc
    s_cbranch_execz R_T0
    buffer_load_dwordx3 v[112:114], v44, s[44:47], s7 offen offset:192 sc1
R_T0:
    s_mov_b64 exec, -1
    v_cmp_lt_i32 vcc, 32, v129
    s_mov_b64 exec, vcc
    s_cbranch_execz R_T1
    buffer_load_dwordx3 v[116:118], v45, s[44:47], s7 offen offset:192 sc1
R_T1:
    s_mov_b64 exec, -1
    v_cmp_lt_i32 vcc, 32, v130
    s_mov_b64 exec, vcc
    s_cbranch_execz R_T2
    buffer_load_dwordx3 v[120:122], v46, s[44:47], s7 offen offset:192 sc1
R_T2:
    s_mov_b64 exec, -1
    v_cmp_lt_i32 vcc, 32, v131
    s_mov_b64 exec, vcc
    s_cbranch_execz R_T3
    buffer_load_dwordx3 v[124:126], v47, s[44:47], s7 offen offset:192 sc1
R_T3:
    s_mov_b64 exec, -1
    s_waitcnt vmcnt(0)
    v_lshrrev_b32_e64 v115, 16, v113
    v_and_b32 v113, 0xff, v113
    v_cmp_lt_i32 vcc, 32, v128
    s_mov_b64 exec, vcc
    ds_add_rtn_u32 v96, v113, v55 offset:2048
    v_max_f32_e64 v12, |v112|, v12
    s_mov_b64 exec, -1
    v_cmp_lt_i32 vcc, 33, v128
    s_mov_b64 exec, vcc
    ds_add_rtn_u32 v97, v115, v55 offset:2048
    v_max_f32_e64 v12, |v114|, v12
    s_mov_b64 exec, -1
    v_lshrrev_b32 v119, 16, v117
    v_and_b32 v117, 0xff, v117
    v_cmp_lt_i32_e64 vcc, 32, v129
    s_mov_b64 exec, vcc
    ds_add_rtn_u32 v98, v117, v55 offset:2048
    v_max_f32_e64 v12, |v116|, v12
    s_mov_b64 exec, -1
    v_cmp_lt_i32_e64 vcc, 33, v129
    s_mov_b64 exec, vcc
    ds_add_rtn_u32 v99, v119, v55 offset:2048
    v_max_f32_e64 v12, |v118|, v12
    s_mov_b64 exec, -1
    v_lshrrev_b32 v123, 16, v121
    v_and_b32 v121, 0xff, v121
    v_cmp_lt_i32 vcc, 32, v130
    s_mov_b64 exec, vcc
    ds_add_rtn_u32 v100, v121, v55 offset:2048
    v_max_f32_e64 v12, |v120|, v12
    s_mov_b64 exec, -1
    v_cmp_lt_i32_e64 vcc, 33, v130
    s_mov_b64 exec, vcc
    ds_add_rtn_u32 v101, v123, v55 offset:2048
    v_max_f32_e64 v12, |v122|, v12
    s_mov_b64 exec, -1
    v_lshrrev_b32 v127, 16, v125
    v_and_b32 v125, 0xff, v125
    v_cmp_lt_i32 vcc, 32, v131
    s_mov_b64 exec, vcc
    ds_add_rtn_u32 v102, v125, v55 offset:2048
    v_max_f32_e64 v12, |v124|, v12
    s_mov_b64 exec, -1
    v_cmp_lt_i32 vcc, 33, v131
    s_mov_b64 exec, vcc
    ds_add_rtn_u32 v103, v127, v55 offset:2048
    v_max_f32_e64 v12, |v126|, v12
    s_mov_b64 exec, -1
    s_waitcnt lgkmcnt(0)
    v_cmp_lt_i32 vcc, 32, v128
    s_mov_b64 exec, vcc
    ds_write_b32 v96, v112
    s_mov_b64 exec, -1
    v_cmp_lt_i32 vcc, 33, v128
    s_mov_b64 exec, vcc
    ds_write_b32 v97, v114
    s_mov_b64 exec, -1
    v_cmp_lt_i32 vcc, 32, v129
    s_mov_b64 exec, vcc
    ds_write_b32 v98, v116
    s_mov_b64 exec, -1
    v_cmp_lt_i32 vcc, 33, v129
    s_mov_b64 exec, vcc
    ds_write_b32 v99, v118
    s_mov_b64 exec, -1
    v_cmp_lt_i32 vcc, 32, v130
    s_mov_b64 exec, vcc
    ds_write_b32 v100, v120
    s_mov_b64 exec, -1
    v_cmp_lt_i32 vcc, 33, v130
    s_mov_b64 exec, vcc
    ds_write_b32 v101, v122
    s_mov_b64 exec, -1
    v_cmp_lt_i32_e64 vcc, 32, v131
    s_mov_b64 exec, vcc
    ds_write_b32 v102, v124
    s_mov_b64 exec, -1
    v_cmp_lt_i32 vcc, 33, v131
    s_mov_b64 exec, vcc
    ds_write_b32 v103, v126
    s_mov_b64 exec, -1
    s_waitcnt lgkmcnt(0)
    s_branch R_THIRDB
R_COMPACT:
    s_cmp_gt_u32 s64, 32
    s_cselect_b32 s64, 128, s64
    s_cbranch_scc1 R_SHRINK
    s_barrier
    v_lshlrev_b32 v48, 4, v13
    v_add_u32 v49, 133888, v48
    v_mov_b32 v40, 0xf000
    v_mov_b32 v41, 0xf000
    v_mov_b32 v42, 0xf000
    v_mov_b32 v43, 0xf000
    ds_write_b128 v49, v[40:43] offset:0
    ds_write_b128 v49, v[40:43] offset:8192
    ds_write_b128 v49, v[40:43] offset:16384
    ds_write_b128 v49, v[40:43] offset:18208
    v_add_lshl_u32 v44, v36, v14, 5
    v_add_u32 v44, 133888, v44
    v_sub_u32 v44, v44, v250
    v_add_u32 v39, v39, v44
    ds_bpermute_b32 v113, v113, v44
    ds_bpermute_b32 v115, v115, v44
    ds_bpermute_b32 v117, v117, v44
    ds_bpermute_b32 v119, v119, v44
    ds_bpermute_b32 v121, v121, v44
    ds_bpermute_b32 v123, v123, v44
    ds_bpermute_b32 v125, v125, v44
    ds_bpermute_b32 v127, v127, v44
    ds_bpermute_b32 v129, v129, v44
    ds_bpermute_b32 v131, v131, v44
    ds_bpermute_b32 v133, v133, v44
    ds_bpermute_b32 v135, v135, v44
    ds_bpermute_b32 v137, v137, v44
    ds_bpermute_b32 v139, v139, v44
    ds_bpermute_b32 v141, v141, v44
    ds_bpermute_b32 v143, v143, v44
    v_lshlrev_b32_e64 v45, 2, v251
    v_add_u32 v45, 98304, v45
    v_lshl_add_u32 v46, v35, 5, v39
    s_mov_b32 exec_lo, 0x3cf3cf3c
    s_mov_b32 exec_hi, 0xf3cf
    ds_write_b32 v45, v46
    s_mov_b64 exec, -1
    s_waitcnt lgkmcnt(0)
    s_barrier
    v_add_u32 v96, v96, v113
    v_add_u32 v97, v97, v115
    v_add_u32 v98, v98, v117
    v_add_u32 v99, v99, v119
    v_add_u32 v100, v100, v121
    v_add_u32 v101, v101, v123
    v_add_u32 v102, v102, v125
    v_add_u32 v103, v103, v127
    v_add_u32 v104, v104, v129
    v_add_u32 v105, v105, v131
    v_add_u32 v106, v106, v133
    v_add_u32 v107, v107, v135
    v_add_u32 v108, v108, v137
    v_add_u32 v109, v109, v139
    v_add_u32 v110, v110, v141
    v_add_u32 v111, v111, v143
    s_mov_b64 exec, s[24:25]
    ds_write_b32 v104, v128
    s_mov_b64 exec, s[26:27]
    ds_write_b32 v105, v130
R_D9:
    s_mov_b64 exec, s[28:29]
    ds_write_b32 v106, v132
    s_mov_b64 exec, s[30:31]
    ds_write_b32 v107, v134
R_D11:
    s_mov_b64 exec, s[32:33]
    ds_write_b32 v108, v136
    s_mov_b64 exec, s[34:35]
    ds_write_b32 v109, v138
R_D13:
    s_mov_b64 exec, s[36:37]
    ds_write_b32 v110, v140
    s_mov_b64 exec, s[38:39]
    ds_write_b32 v111, v142
R_D15:
    s_mov_b64 exec, s[8:9]
    ds_write_b32 v96, v112
    s_mov_b64 exec, s[10:11]
    ds_write_b32 v97, v114
    s_mov_b64 exec, s[12:13]
    ds_write_b32 v98, v116
    s_mov_b64 exec, s[14:15]
    ds_write_b32 v99, v118
    s_mov_b64 exec, s[16:17]
    s_nop 0
    ds_write_b32 v100, v120
    s_mov_b64 exec, s[18:19]
    ds_write_b32 v101, v122
    s_mov_b64 exec, s[20:21]
    ds_write_b32 v102, v124
    s_mov_b64 exec, s[22:23]
    ds_write_b32 v103, v126
    s_mov_b64 exec, -1
    s_mov_b32 s69, 0
    s_branch R_TABLE
TWAITF:
    s_setprio 0
    s_sub_u32 s70, s70, 1
    s_cbranch_scc1 K_END
    ds_read_b32 v31, v53 offset:2320
    ds_read_u16 v3, v15 offset:16
    ds_read_u16 v4, v28 offset:16
    s_branch TCHKF
TWAITS:
    s_setprio 0
    s_sub_u32 s70, s70, 1
    s_cbranch_scc1 K_END
    ds_read_b32 v31, v53 offset:2320
    ds_read_u16 v3, v15 offset:16
    ds_read_u16 v4, v28 offset:16
    s_branch TCHKS
R_LATE:
    s_waitcnt lgkmcnt(0)
    s_barrier
WAVE_REDO:
    s_setprio 0
    s_waitcnt vmcnt(0)
    v_mov_b32 v15, v240
    v_mov_b32 v28, v241
    v_mov_b32 v5, v242
    v_mov_b32_e64 v6, v243
    ds_read_u16 v3, v15
    ds_read_u16 v4, v28
    ds_read_u16 v10, v5 offset:2
    v_mov_b32 v16, 0
    v_mov_b32 v18, 1.0
    v_mov_b32 v17, 0
    v_mov_b32 v19, 1.0
    v_mov_b32 v12, 0
    v_mov_b32 v65, v2
    v_mov_b32 v67, v2
    v_mov_b32 v69, v2
    v_mov_b32_e64 v71, v2
    v_pk_mul_f32 v[76:77], v[16:17], v[16:17]
    v_pk_mul_f32 v[78:79], v[16:17], v[16:17]
    v_pk_mul_f32 v[80:81], v[16:17], v[16:17]
    v_pk_mul_f32 v[82:83], v[16:17], v[16:17]
    v_pk_mul_f32 v[84:85], v[16:17], v[16:17]
    v_pk_mul_f32 v[86:87], v[16:17], v[16:17]
    v_pk_mul_f32 v[88:89], v[16:17], v[16:17]
    v_pk_mul_f32 v[90:91], v[16:17], v[16:17]
    v_pk_mul_f32 v[92:93], v[16:17], v[16:17]
    v_pk_mul_f32 v[94:95], v[16:17], v[16:17]
    v_pk_mul_f32 v[144:145], v[16:17], v[16:17]
    v_pk_mul_f32 v[146:147], v[16:17], v[16:17]
    v_pk_mul_f32 v[148:149], v[16:17], v[16:17]
    v_pk_mul_f32 v[150:151], v[16:17], v[16:17]
    v_pk_mul_f32 v[152:153], v[16:17], v[16:17]
    v_pk_mul_f32 v[154:155], v[16:17], v[16:17]
    v_pk_mul_f32 v[156:157], v[16:17], v[16:17]
    v_pk_mul_f32 v[158:159], v[16:17], v[16:17]
    v_pk_mul_f32 v[160:161], v[16:17], v[16:17]
    v_pk_mul_f32 v[162:163], v[16:17], v[16:17]
    v_pk_mul_f32 v[164:165], v[16:17], v[16:17]
    v_pk_mul_f32 v[166:167], v[16:17], v[16:17]
    v_pk_mul_f32 v[168:169], v[16:17], v[16:17]
    v_pk_mul_f32 v[170:171], v[16:17], v[16:17]
    v_pk_mul_f32 v[172:173], v[16:17], v[16:17]
    v_pk_mul_f32 v[174:175], v[16:17], v[16:17]
    s_waitcnt lgkmcnt(0)
    v_add_u32 v3, v3, v29
    v_add_u32_e64 v4, v4, v30
    v_mad_u32_u24 v11, v10, v8, v9
    ds_read_u16 v64, v3 offset:0
    ds_read_u16 v66, v3 offset:4
    ds_read_u16 v68, v3 offset:8
    ds_read_u16 v70, v3 offset:12
    ds_read_b32 v26, v4
    s_mov_b32 m0, s62
    s_waitcnt lgkmcnt(0)
    buffer_load_dwordx4 v[64:65], s[48:51], s52 idxen offen offset:0 sc1 lds
    buffer_load_dwordx4 v[66:67], s[48:51], s53 idxen offen offset:1024 sc1 lds
    buffer_load_dwordx4 v[68:69], s[48:51], s54 idxen offen offset:2048 sc1 lds
    buffer_load_dwordx4 v[70:71], s[48:51], s55 idxen offen offset:3072 sc1 lds
    s_waitcnt lgkmcnt(0)
    s_branch WAVE_GO
.p2align 3
PEELS:
    v_exp_f32 v96, v112
    s_setprio 3
    v_mfma_f32_32x32x8_bf16 v[128:143], v[22:23], v[74:75], v[160:175]
    v_exp_f32 v97, v113
    v_rcp_f32 v20, v18
    v_rcp_f32 v21, v19
    v_exp_f32 v98, v114
    v_exp_f32 v99, v115
    v_exp_f32 v100, v116
    v_exp_f32 v101, v117
    v_exp_f32 v102, v118
    v_exp_f32 v103, v119
    v_exp_f32 v104, v120
    v_exp_f32 v105, v121
    v_exp_f32 v106, v122
    v_exp_f32 v107, v123
    v_exp_f32 v108, v124
    v_exp_f32 v109, v125
    v_exp_f32 v110, v126
    v_exp_f32_e64 v111, v127
    v_pk_mul_f32 v[20:21], v[16:17], v[20:21]
    v_pk_add_f32 v[96:97], v[96:97], 1.0 op_sel_hi:[1,0]
    v_pk_add_f32 v[98:99], v[98:99], 1.0 op_sel_hi:[1,0]
    v_pk_add_f32 v[100:101], v[100:101], 1.0 op_sel_hi:[1,0]
    v_pk_add_f32 v[102:103], v[102:103], 1.0 op_sel_hi:[1,0]
    v_pk_add_f32 v[104:105], v[104:105], 1.0 op_sel_hi:[1,0]
    v_pk_add_f32 v[106:107], v[106:107], 1.0 op_sel_hi:[1,0]
    v_pk_add_f32 v[108:109], v[108:109], 1.0 op_sel_hi:[1,0]
    v_pk_add_f32 v[110:111], v[110:111], 1.0 op_sel_hi:[1,0]
    v_cvt_pk_bf16_f32 v95, v20, v21
    v_rcp_f32 v96, v96
    v_rcp_f32 v97, v97
    v_rcp_f32 v98, v98
    v_rcp_f32 v99, v99
    v_rcp_f32 v100, v100
    v_rcp_f32 v101, v101
    v_rcp_f32 v102, v102
    v_rcp_f32 v103, v103
    v_rcp_f32 v104, v104
    v_rcp_f32 v105, v105
    v_rcp_f32 v106, v106
    v_rcp_f32 v107, v107
    v_rcp_f32 v108, v108
    v_rcp_f32 v109, v109
    v_rcp_f32 v110, v110
    v_rcp_f32 v111, v111
    v_pk_mul_f32 v[16:17], v[112:113], v[96:97]
    v_pk_fma_f32 v[16:17], v[114:115], v[98:99], v[16:17]
    v_pk_fma_f32 v[16:17], v[116:117], v[100:101], v[16:17]
    v_pk_fma_f32 v[16:17], v[118:119], v[102:103], v[16:17]
    v_pk_fma_f32 v[16:17], v[120:121], v[104:105], v[16:17]
    v_pk_fma_f32 v[16:17], v[122:123], v[106:107], v[16:17]
    v_pk_fma_f32 v[16:17], v[124:125], v[108:109], v[16:17]
    v_pk_fma_f32 v[16:17], v[126:127], v[110:111], v[16:17]
TCHKS:
    s_waitcnt lgkmcnt(0)
    v_readfirstlane_b32 s5, v31
    v_add_u32 v3, v3, v29
    v_add_u32 v4, v4, v30
    s_cmp_lt_u32 s5, s71
    s_cbranch_scc1 TWAITS
    ds_read_u16 v64, v3 offset:0
    ds_read_u16 v66, v3 offset:4
    ds_read_u16 v68, v3 offset:8
    ds_read_u16 v70, v3 offset:12
    s_setprio 0
    s_waitcnt lgkmcnt(0)
    buffer_load_dwordx4 v[64:65], s[48:51], s52 idxen offen offset:0 sc1 lds
    buffer_load_dwordx4 v[66:67], s[48:51], s53 idxen offen offset:1024 sc1 lds
    buffer_load_dwordx4 v[68:69], s[48:51], s54 idxen offen offset:2048 sc1 lds
    buffer_load_dwordx4 v[70:71], s[48:51], s55 idxen offen offset:3072 sc1 lds
LOOPS:
SLOTS0:
    s_setprio 0
    s_waitcnt vmcnt(4)
    ds_read_u16_d16_hi v144, v1 offset:4096
    ds_read_u16_d16_hi v145, v1 offset:4352
    ds_read_u16_d16_hi v146, v1 offset:5120
    ds_read_u16_d16_hi v147, v1 offset:5376
    ds_read_u16_d16_hi v148, v1 offset:6144
    ds_read_u16_d16_hi v149, v1 offset:6400
    ds_read_u16_d16_hi v150, v1 offset:7168
    ds_read_u16_d16_hi v151, v1 offset:7424
    ds_read_u16_d16_hi v152, v1 offset:4224
    ds_read_u16_d16_hi v153, v1 offset:4480
    ds_read_u16_d16_hi v154, v1 offset:5248
    ds_read_u16_d16_hi v155, v1 offset:5504
    ds_read_u16_d16_hi v156, v1 offset:6272
    ds_read_u16_d16_hi v157, v1 offset:6528
    ds_read_u16_d16_hi v158, v1 offset:7296
    ds_read_u16_d16_hi v159, v1 offset:7552
    ds_read_u16_d16_hi v160, v1 offset:4160
    ds_read_u16_d16_hi v161, v1 offset:4416
    ds_read_u16_d16_hi v162, v1 offset:5184
    ds_read_u16_d16_hi v163, v1 offset:5440
    ds_read_u16_d16_hi v164, v1 offset:6208
    ds_read_u16_d16_hi v165, v1 offset:6464
    ds_read_u16_d16_hi v166, v1 offset:7232
    ds_read_u16_d16_hi v167, v1 offset:7488
    ds_read_u16_d16_hi v168, v1 offset:4288
    ds_read_u16_d16_hi v169, v1 offset:4544
    ds_read_u16_d16_hi v170, v1 offset:5312
    ds_read_u16_d16_hi v171, v1 offset:5568
    ds_read_u16_d16_hi v172, v1 offset:6336
    ds_read_u16_d16_hi v173, v1 offset:6592
    ds_read_u16_d16_hi v174, v1 offset:7360
    ds_read_u16_d16_hi v175, v1 offset:7616
    ds_read_b64_tr_b16 v[72:73], v11 offset:128
    ds_read_b64_tr_b16 v[74:75], v11 offset:192
    ds_read_u16 v3, v15 offset:32
    ds_read_b32 v26, v4
    ds_read_u16 v10, v5 offset:18
    s_mov_b32 m0, s63
    s_cmp_eq_u32 s61, 0
    s_waitcnt lgkmcnt(0)
    s_cbranch_scc1 SKDS0
    buffer_load_dwordx4 v[64:65], s[48:51], s56 idxen offen offset:0 sc1 lds
    buffer_load_dwordx4 v[66:67], s[48:51], s57 idxen offen offset:1024 sc1 lds
    buffer_load_dwordx4 v[68:69], s[48:51], s58 idxen offen offset:2048 sc1 lds
    buffer_load_dwordx4 v[70:71], s[48:51], s59 idxen offen offset:3072 sc1 lds
SKDS0:
    v_exp_f32 v96, v128
    v_exp_f32 v97, v129
    v_mfma_f32_32x32x16_bf16 v[192:207], v[84:87], v[76:79], v[192:207]
    s_setprio 3
    v_rcp_f32 v20, v18
    v_rcp_f32 v21, v19
    v_exp_f32 v98, v130
    v_mfma_f32_32x32x16_bf16 v[208:223], v[88:91], v[76:79], v[208:223]
    v_exp_f32 v99, v131
    v_exp_f32 v100, v132
    v_exp_f32 v101, v133
    v_exp_f32 v102, v134
    v_mfma_f32_32x32x8_bf16 v[112:127], v[22:23], v[72:73], v[144:159]
    v_exp_f32 v103, v135
    v_exp_f32 v104, v136
    v_exp_f32 v105, v137
    v_exp_f32 v106, v138
    v_exp_f32 v107, v139
    v_exp_f32 v108, v140
    v_exp_f32 v109, v141
    v_exp_f32 v110, v142
    v_exp_f32 v111, v143
    v_add_u32 v3, v3, v29
    v_perm_b32 v26, v26, v26, v7
    v_pk_mul_f32 v[20:21], v[16:17], v[20:21]
    v_pk_add_f32 v[96:97], v[96:97], 1.0 op_sel_hi:[1,0]
    v_pk_add_f32 v[98:99], v[98:99], 1.0 op_sel_hi:[1,0]
    v_pk_add_f32 v[100:101], v[100:101], 1.0 op_sel_hi:[1,0]
    v_pk_add_f32 v[102:103], v[102:103], 1.0 op_sel_hi:[1,0]
    v_pk_add_f32 v[104:105], v[104:105], 1.0 op_sel_hi:[1,0]
    v_pk_add_f32 v[106:107], v[106:107], 1.0 op_sel_hi:[1,0]
    v_pk_add_f32 v[108:109], v[108:109], 1.0 op_sel_hi:[1,0]
    v_pk_add_f32 v[110:111], v[110:111], 1.0 op_sel_hi:[1,0]
    v_cvt_pk_bf16_f32 v80, v20, v21
    v_rcp_f32 v96, v96
    v_rcp_f32 v97, v97
    v_rcp_f32 v98, v98
    v_rcp_f32 v99, v99
    v_rcp_f32 v100, v100
    v_rcp_f32 v101, v101
    v_rcp_f32 v102, v102
    v_rcp_f32 v103, v103
    v_rcp_f32 v104, v104
    v_rcp_f32 v105, v105
    v_rcp_f32 v106, v106
    v_rcp_f32 v107, v107
    v_rcp_f32 v108, v108
    v_rcp_f32 v109, v109
    v_rcp_f32 v110, v110
    v_rcp_f32 v111, v111
    v_pk_mul_f32 v[16:17], v[128:129], v[96:97]
    v_pk_fma_f32 v[16:17], v[130:131], v[98:99], v[16:17]
    v_pk_fma_f32 v[16:17], v[132:133], v[100:101], v[16:17]
    v_pk_fma_f32 v[16:17], v[134:135], v[102:103], v[16:17]
    v_pk_fma_f32 v[16:17], v[136:137], v[104:105], v[16:17]
    v_pk_fma_f32 v[16:17], v[138:139], v[106:107], v[16:17]
    v_pk_fma_f32 v[16:17], v[140:141], v[108:109], v[16:17]
    v_pk_fma_f32 v[16:17], v[142:143], v[110:111], v[16:17]
    v_mfma_f32_32x32x8_bf16 v[128:143], v[22:23], v[74:75], v[160:175]
    v_exp_f32 v96, v112
    v_exp_f32 v97, v113
    v_rcp_f32 v20, v18
    v_rcp_f32 v21, v19
    v_exp_f32 v98, v114
    v_exp_f32 v99, v115
    v_exp_f32 v100, v116
    v_exp_f32 v101, v117
    v_exp_f32 v102, v118
    v_exp_f32 v103, v119
    v_exp_f32 v104, v120
    v_exp_f32 v105, v121
    v_exp_f32 v106, v122
    v_exp_f32 v107, v123
    v_exp_f32 v108, v124
    v_exp_f32 v109, v125
    v_exp_f32 v110, v126
    v_exp_f32 v111, v127
    v_mad_u32_u24 v11, v10, v8, v9
    v_pk_mul_f32 v[20:21], v[16:17], v[20:21]
    v_pk_add_f32 v[96:97], v[96:97], 1.0 op_sel_hi:[1,0]
    v_pk_add_f32 v[98:99], v[98:99], 1.0 op_sel_hi:[1,0]
    v_pk_add_f32 v[100:101], v[100:101], 1.0 op_sel_hi:[1,0]
    v_pk_add_f32 v[102:103], v[102:103], 1.0 op_sel_hi:[1,0]
    v_pk_add_f32 v[104:105], v[104:105], 1.0 op_sel_hi:[1,0]
    v_pk_add_f32 v[106:107], v[106:107], 1.0 op_sel_hi:[1,0]
    v_pk_add_f32 v[108:109], v[108:109], 1.0 op_sel_hi:[1,0]
    v_pk_add_f32 v[110:111], v[110:111], 1.0 op_sel_hi:[1,0]
    v_cvt_pk_bf16_f32 v84, v20, v21
    v_pk_fma_f32 v[22:23], v[24:25], v[26:27], v[252:253] op_sel_hi:[1,0,1]
    v_rcp_f32 v96, v96
    v_rcp_f32 v97, v97
    v_rcp_f32 v98, v98
    v_rcp_f32 v99, v99
    v_rcp_f32 v100, v100
    v_rcp_f32 v101, v101
    v_rcp_f32 v102, v102
    v_rcp_f32 v103, v103
    v_rcp_f32 v104, v104
    v_rcp_f32 v105, v105
    v_rcp_f32 v106, v106
    v_rcp_f32 v107, v107
    v_rcp_f32 v108, v108
    v_rcp_f32 v109, v109
    v_rcp_f32 v110, v110
    v_rcp_f32 v111, v111
    v_pk_mul_f32 v[16:17], v[112:113], v[96:97]
    v_pk_fma_f32 v[16:17], v[114:115], v[98:99], v[16:17]
    v_pk_fma_f32 v[16:17], v[116:117], v[100:101], v[16:17]
    v_pk_fma_f32 v[16:17], v[118:119], v[102:103], v[16:17]
    v_pk_fma_f32 v[16:17], v[120:121], v[104:105], v[16:17]
    v_pk_fma_f32 v[16:17], v[122:123], v[106:107], v[16:17]
    v_pk_fma_f32 v[16:17], v[124:125], v[108:109], v[16:17]
    v_pk_fma_f32 v[16:17], v[126:127], v[110:111], v[16:17]
    s_sub_u32 s61, s61, 1
    s_cbranch_scc1 TAILS0
    s_setprio 0
    s_waitcnt vmcnt(4)
    ds_read_u16_d16_hi v144, v1 offset:0
    ds_read_u16_d16_hi v145, v1 offset:256
    ds_read_u16_d16_hi v146, v1 offset:1024
    ds_read_u16_d16_hi v147, v1 offset:1280
    ds_read_u16_d16_hi v148, v1 offset:2048
    ds_read_u16_d16_hi v149, v1 offset:2304
    ds_read_u16_d16_hi v150, v1 offset:3072
    ds_read_u16_d16_hi v151, v1 offset:3328
    ds_read_u16_d16_hi v152, v1 offset:128
    ds_read_u16_d16_hi v153, v1 offset:384
    ds_read_u16_d16_hi v154, v1 offset:1152
    ds_read_u16_d16_hi v155, v1 offset:1408
    ds_read_u16_d16_hi v156, v1 offset:2176
    ds_read_u16_d16_hi v157, v1 offset:2432
    ds_read_u16_d16_hi v158, v1 offset:3200
    ds_read_u16_d16_hi v159, v1 offset:3456
    ds_read_u16_d16_hi v160, v1 offset:64
    ds_read_u16_d16_hi v161, v1 offset:320
    ds_read_u16_d16_hi v162, v1 offset:1088
    ds_read_u16_d16_hi v163, v1 offset:1344
    ds_read_u16_d16_hi v164, v1 offset:2112
    ds_read_u16_d16_hi v165, v1 offset:2368
    ds_read_u16_d16_hi v166, v1 offset:3136
    ds_read_u16_d16_hi v167, v1 offset:3392
    ds_read_u16_d16_hi v168, v1 offset:192
    ds_read_u16_d16_hi v169, v1 offset:448
    ds_read_u16_d16_hi v170, v1 offset:1216
    ds_read_u16_d16_hi v171, v1 offset:1472
    ds_read_u16_d16_hi v172, v1 offset:2240
    ds_read_u16_d16_hi v173, v1 offset:2496
    ds_read_u16_d16_hi v174, v1 offset:3264
    ds_read_u16_d16_hi v175, v1 offset:3520
    ds_read_b64_tr_b16 v[72:73], v11 offset:0
    ds_read_b64_tr_b16 v[74:75], v11 offset:64
    ds_read_u16 v64, v3 offset:0
    ds_read_u16 v66, v3 offset:4
    ds_read_u16 v68, v3 offset:8
    ds_read_u16 v70, v3 offset:12
    ds_read_u16 v4, v28 offset:32
    s_mov_b32 m0, s62
    s_waitcnt lgkmcnt(0)
    buffer_load_dwordx4 v[64:65], s[48:51], s52 idxen offen offset:0 sc1 lds
    buffer_load_dwordx4 v[66:67], s[48:51], s53 idxen offen offset:1024 sc1 lds
    buffer_load_dwordx4 v[68:69], s[48:51], s54 idxen offen offset:2048 sc1 lds
    buffer_load_dwordx4 v[70:71], s[48:51], s55 idxen offen offset:3072 sc1 lds
    v_exp_f32 v96, v128
    v_exp_f32 v97, v129
    v_mfma_f32_32x32x16_bf16 v[224:239], v[92:95], v[76:79], v[224:239]
    s_setprio 3
    v_rcp_f32 v20, v18
    v_rcp_f32 v21, v19
    v_exp_f32 v98, v130
    v_mfma_f32_32x32x8_bf16 v[112:127], v[22:23], v[72:73], v[144:159]
    v_exp_f32 v99, v131
    v_exp_f32 v100, v132
    v_exp_f32 v101, v133
    v_exp_f32 v102, v134
    v_exp_f32 v103, v135
    v_exp_f32 v104, v136
    v_exp_f32 v105, v137
    v_exp_f32 v106, v138
    v_exp_f32 v107, v139
    v_exp_f32 v108, v140
    v_exp_f32 v109, v141
    v_exp_f32 v110, v142
    v_exp_f32_e64 v111, v143
    v_pk_mul_f32 v[20:21], v[16:17], v[20:21]
    v_pk_add_f32 v[96:97], v[96:97], 1.0 op_sel_hi:[1,0]
    v_pk_add_f32 v[98:99], v[98:99], 1.0 op_sel_hi:[1,0]
    v_pk_add_f32 v[100:101], v[100:101], 1.0 op_sel_hi:[1,0]
    v_pk_add_f32 v[102:103], v[102:103], 1.0 op_sel_hi:[1,0]
    v_pk_add_f32 v[104:105], v[104:105], 1.0 op_sel_hi:[1,0]
    v_pk_add_f32 v[106:107], v[106:107], 1.0 op_sel_hi:[1,0]
    v_pk_add_f32 v[108:109], v[108:109], 1.0 op_sel_hi:[1,0]
    v_pk_add_f32 v[110:111], v[110:111], 1.0 op_sel_hi:[1,0]
    v_cvt_pk_bf16_f32 v88, v20, v21
    v_rcp_f32 v96, v96
    v_rcp_f32 v97, v97
    v_rcp_f32 v98, v98
    v_rcp_f32 v99, v99
    v_rcp_f32 v100, v100
    v_rcp_f32 v101, v101
    v_rcp_f32 v102, v102
    v_rcp_f32 v103, v103
    v_rcp_f32 v104, v104
    v_rcp_f32 v105, v105
    v_rcp_f32 v106, v106
    v_rcp_f32 v107, v107
    v_rcp_f32 v108, v108
    v_rcp_f32 v109, v109
    v_rcp_f32 v110, v110
    v_rcp_f32 v111, v111
    v_pk_mul_f32 v[16:17], v[128:129], v[96:97]
    v_pk_fma_f32 v[16:17], v[130:131], v[98:99], v[16:17]
    v_pk_fma_f32 v[16:17], v[132:133], v[100:101], v[16:17]
    v_pk_fma_f32 v[16:17], v[134:135], v[102:103], v[16:17]
    v_pk_fma_f32 v[16:17], v[136:137], v[104:105], v[16:17]
    v_pk_fma_f32 v[16:17], v[138:139], v[106:107], v[16:17]
    v_pk_fma_f32 v[16:17], v[140:141], v[108:109], v[16:17]
    v_pk_fma_f32 v[16:17], v[142:143], v[110:111], v[16:17]
    v_mfma_f32_32x32x8_bf16 v[128:143], v[22:23], v[74:75], v[160:175]
    v_exp_f32 v96, v112
    v_exp_f32 v97, v113
    v_rcp_f32 v20, v18
    v_rcp_f32 v21, v19
    v_exp_f32 v98, v114
    v_exp_f32 v99, v115
    v_exp_f32 v100, v116
    v_exp_f32 v101, v117
    v_exp_f32 v102, v118
    v_exp_f32 v103, v119
    v_exp_f32 v104, v120
    v_exp_f32 v105, v121
    v_exp_f32 v106, v122
    v_exp_f32 v107, v123
    v_exp_f32 v108, v124
    v_exp_f32 v109, v125
    v_exp_f32 v110, v126
    v_exp_f32 v111, v127
    v_add_u32_e64 v4, v4, v30
    v_pk_mul_f32 v[20:21], v[16:17], v[20:21]
    v_pk_add_f32 v[96:97], v[96:97], 1.0 op_sel_hi:[1,0]
    v_pk_add_f32 v[98:99], v[98:99], 1.0 op_sel_hi:[1,0]
    v_pk_add_f32 v[100:101], v[100:101], 1.0 op_sel_hi:[1,0]
    v_pk_add_f32 v[102:103], v[102:103], 1.0 op_sel_hi:[1,0]
    v_pk_add_f32 v[104:105], v[104:105], 1.0 op_sel_hi:[1,0]
    v_pk_add_f32 v[106:107], v[106:107], 1.0 op_sel_hi:[1,0]
    v_pk_add_f32 v[108:109], v[108:109], 1.0 op_sel_hi:[1,0]
    v_pk_add_f32 v[110:111], v[110:111], 1.0 op_sel_hi:[1,0]
    v_cvt_pk_bf16_f32 v92, v20, v21
    v_rcp_f32 v96, v96
    v_rcp_f32 v97, v97
    v_rcp_f32 v98, v98
    v_rcp_f32 v99, v99
    v_rcp_f32 v100, v100
    v_rcp_f32 v101, v101
    v_rcp_f32 v102, v102
    v_rcp_f32 v103, v103
    v_rcp_f32 v104, v104
    v_rcp_f32 v105, v105
    v_rcp_f32 v106, v106
    v_rcp_f32 v107, v107
    v_rcp_f32 v108, v108
    v_rcp_f32 v109, v109
    v_rcp_f32 v110, v110
    v_rcp_f32 v111, v111
    v_pk_mul_f32 v[16:17], v[112:113], v[96:97]
    v_pk_fma_f32 v[16:17], v[114:115], v[98:99], v[16:17]
    v_pk_fma_f32 v[16:17], v[116:117], v[100:101], v[16:17]
    v_pk_fma_f32 v[16:17], v[118:119], v[102:103], v[16:17]
    v_pk_fma_f32 v[16:17], v[120:121], v[104:105], v[16:17]
    v_pk_fma_f32 v[16:17], v[122:123], v[106:107], v[16:17]
    v_pk_fma_f32 v[16:17], v[124:125], v[108:109], v[16:17]
    v_pk_fma_f32 v[16:17], v[126:127], v[110:111], v[16:17]
SLOTS1:
    s_setprio 0
    s_waitcnt vmcnt(4)
    ds_read_u16_d16_hi v144, v1 offset:4096
    ds_read_u16_d16_hi v145, v1 offset:4352
    ds_read_u16_d16_hi v146, v1 offset:5120
    ds_read_u16_d16_hi v147, v1 offset:5376
    ds_read_u16_d16_hi v148, v1 offset:6144
    ds_read_u16_d16_hi v149, v1 offset:6400
    ds_read_u16_d16_hi v150, v1 offset:7168
    ds_read_u16_d16_hi v151, v1 offset:7424
    ds_read_u16_d16_hi v152, v1 offset:4224
    ds_read_u16_d16_hi v153, v1 offset:4480
    ds_read_u16_d16_hi v154, v1 offset:5248
    ds_read_u16_d16_hi v155, v1 offset:5504
    ds_read_u16_d16_hi v156, v1 offset:6272
    ds_read_u16_d16_hi v157, v1 offset:6528
    ds_read_u16_d16_hi v158, v1 offset:7296
    ds_read_u16_d16_hi v159, v1 offset:7552
    ds_read_u16_d16_hi v160, v1 offset:4160
    ds_read_u16_d16_hi v161, v1 offset:4416
    ds_read_u16_d16_hi v162, v1 offset:5184
    ds_read_u16_d16_hi v163, v1 offset:5440
    ds_read_u16_d16_hi v164, v1 offset:6208
    ds_read_u16_d16_hi v165, v1 offset:6464
    ds_read_u16_d16_hi v166, v1 offset:7232
    ds_read_u16_d16_hi v167, v1 offset:7488
    ds_read_u16_d16_hi v168, v1 offset:4288
    ds_read_u16_d16_hi v169, v1 offset:4544
    ds_read_u16_d16_hi v170, v1 offset:5312
    ds_read_u16_d16_hi v171, v1 offset:5568
    ds_read_u16_d16_hi v172, v1 offset:6336
    ds_read_u16_d16_hi v173, v1 offset:6592
    ds_read_u16_d16_hi v174, v1 offset:7360
    ds_read_u16_d16_hi v175, v1 offset:7616
    ds_read_b64_tr_b16 v[72:73], v11 offset:128
    ds_read_b64_tr_b16 v[74:75], v11 offset:192
    ds_read_u16 v3, v15 offset:48
    ds_read_b32 v26, v4
    ds_read_u16 v10, v5 offset:34
    ds_read_b32 v76, v6
    ds_read_b32 v77, v6 offset:128
    s_mov_b32 m0, s63
    s_cmp_eq_u32 s61, 0
    s_waitcnt lgkmcnt(0)
    s_cbranch_scc1 SKDS1
    buffer_load_dwordx4 v[64:65], s[48:51], s56 idxen offen offset:0 sc1 lds
    buffer_load_dwordx4 v[66:67], s[48:51], s57 idxen offen offset:1024 sc1 lds
    buffer_load_dwordx4 v[68:69], s[48:51], s58 idxen offen offset:2048 sc1 lds
    buffer_load_dwordx4 v[70:71], s[48:51], s59 idxen offen offset:3072 sc1 lds
SKDS1:
    v_exp_f32 v96, v128
    s_setprio 3
    v_mfma_f32_32x32x8_bf16 v[112:127], v[22:23], v[72:73], v[144:159]
    v_exp_f32 v97, v129
    v_rcp_f32 v20, v18
    v_rcp_f32 v21, v19
    v_exp_f32 v98, v130
    v_exp_f32 v99, v131
    v_exp_f32 v100, v132
    v_exp_f32 v101, v133
    v_exp_f32 v102, v134
    v_exp_f32 v103, v135
    v_exp_f32 v104, v136
    v_exp_f32 v105, v137
    v_exp_f32 v106, v138
    v_exp_f32 v107, v139
    v_exp_f32 v108, v140
    v_exp_f32 v109, v141
    v_exp_f32 v110, v142
    v_exp_f32 v111, v143
    v_add_u32 v3, v3, v29
    v_perm_b32 v26, v26, v26, v7
    v_pk_mul_f32 v[20:21], v[16:17], v[20:21]
    v_pk_add_f32 v[96:97], v[96:97], 1.0 op_sel_hi:[1,0]
    v_pk_add_f32 v[98:99], v[98:99], 1.0 op_sel_hi:[1,0]
    v_pk_add_f32 v[100:101], v[100:101], 1.0 op_sel_hi:[1,0]
    v_pk_add_f32 v[102:103], v[102:103], 1.0 op_sel_hi:[1,0]
    v_pk_add_f32 v[104:105], v[104:105], 1.0 op_sel_hi:[1,0]
    v_pk_add_f32 v[106:107], v[106:107], 1.0 op_sel_hi:[1,0]
    v_pk_add_f32 v[108:109], v[108:109], 1.0 op_sel_hi:[1,0]
    v_pk_add_f32 v[110:111], v[110:111], 1.0 op_sel_hi:[1,0]
    v_cvt_pk_bf16_f32 v81, v20, v21
    v_rcp_f32 v96, v96
    v_rcp_f32 v97, v97
    v_rcp_f32 v98, v98
    v_rcp_f32 v99, v99
    v_rcp_f32 v100, v100
    v_rcp_f32 v101, v101
    v_rcp_f32 v102, v102
    v_rcp_f32 v103, v103
    v_rcp_f32 v104, v104
    v_rcp_f32 v105, v105
    v_rcp_f32 v106, v106
    v_rcp_f32 v107, v107
    v_rcp_f32 v108, v108
    v_rcp_f32 v109, v109
    v_rcp_f32 v110, v110
    v_rcp_f32 v111, v111
    v_pk_mul_f32 v[16:17], v[128:129], v[96:97]
    v_pk_fma_f32 v[16:17], v[130:131], v[98:99], v[16:17]
    v_pk_fma_f32 v[16:17], v[132:133], v[100:101], v[16:17]
    v_pk_fma_f32 v[16:17], v[134:135], v[102:103], v[16:17]
    v_pk_fma_f32 v[16:17], v[136:137], v[104:105], v[16:17]
    v_pk_fma_f32 v[16:17], v[138:139], v[106:107], v[16:17]
    v_pk_fma_f32 v[16:17], v[140:141], v[108:109], v[16:17]
    v_pk_fma_f32 v[16:17], v[142:143], v[110:111], v[16:17]
    v_mfma_f32_32x32x8_bf16 v[128:143], v[22:23], v[74:75], v[160:175]
    v_exp_f32 v96, v112
    v_exp_f32 v97, v113
    v_rcp_f32 v20, v18
    v_rcp_f32 v21, v19
    v_exp_f32 v98, v114
    v_exp_f32 v99, v115
    v_exp_f32 v100, v116
    v_exp_f32 v101, v117
    v_exp_f32 v102, v118
    v_exp_f32 v103, v119
    v_exp_f32 v104, v120
    v_exp_f32 v105, v121
    v_exp_f32 v106, v122
    v_exp_f32 v107, v123
    v_exp_f32 v108, v124
    v_exp_f32 v109, v125
    v_exp_f32 v110, v126
    v_exp_f32 v111, v127
    v_mad_u32_u24 v11, v10, v8, v9
    v_pk_mul_f32 v[20:21], v[16:17], v[20:21]
    v_pk_add_f32 v[96:97], v[96:97], 1.0 op_sel_hi:[1,0]
    v_pk_add_f32 v[98:99], v[98:99], 1.0 op_sel_hi:[1,0]
    v_pk_add_f32 v[100:101], v[100:101], 1.0 op_sel_hi:[1,0]
    v_pk_add_f32 v[102:103], v[102:103], 1.0 op_sel_hi:[1,0]
    v_pk_add_f32 v[104:105], v[104:105], 1.0 op_sel_hi:[1,0]
    v_pk_add_f32 v[106:107], v[106:107], 1.0 op_sel_hi:[1,0]
    v_pk_add_f32 v[108:109], v[108:109], 1.0 op_sel_hi:[1,0]
    v_pk_add_f32 v[110:111], v[110:111], 1.0 op_sel_hi:[1,0]
    v_cvt_pk_bf16_f32 v85, v20, v21
    v_pk_fma_f32 v[22:23], v[24:25], v[26:27], v[252:253] op_sel_hi:[1,0,1]
    v_rcp_f32 v96, v96
    v_rcp_f32 v97, v97
    v_rcp_f32 v98, v98
    v_rcp_f32 v99, v99
    v_rcp_f32 v100, v100
    v_rcp_f32 v101, v101
    v_rcp_f32 v102, v102
    v_rcp_f32 v103, v103
    v_rcp_f32 v104, v104
    v_rcp_f32 v105, v105
    v_rcp_f32 v106, v106
    v_rcp_f32 v107, v107
    v_rcp_f32 v108, v108
    v_rcp_f32 v109, v109
    v_rcp_f32 v110, v110
    v_rcp_f32 v111, v111
    v_pk_mul_f32 v[16:17], v[112:113], v[96:97]
    v_pk_fma_f32 v[16:17], v[114:115], v[98:99], v[16:17]
    v_pk_fma_f32 v[16:17], v[116:117], v[100:101], v[16:17]
    v_pk_fma_f32 v[16:17], v[118:119], v[102:103], v[16:17]
    v_pk_fma_f32 v[16:17], v[120:121], v[104:105], v[16:17]
    v_pk_fma_f32 v[16:17], v[122:123], v[106:107], v[16:17]
    v_pk_fma_f32 v[16:17], v[124:125], v[108:109], v[16:17]
    v_pk_fma_f32 v[16:17], v[126:127], v[110:111], v[16:17]
    s_sub_u32 s61, s61, 1
    s_cbranch_scc1 TAILS1
    s_setprio 0
    s_waitcnt vmcnt(4)
    ds_read_u16_d16_hi v144, v1 offset:0
    ds_read_u16_d16_hi v145, v1 offset:256
    ds_read_u16_d16_hi v146, v1 offset:1024
    ds_read_u16_d16_hi v147, v1 offset:1280
    ds_read_u16_d16_hi v148, v1 offset:2048
    ds_read_u16_d16_hi v149, v1 offset:2304
    ds_read_u16_d16_hi v150, v1 offset:3072
    ds_read_u16_d16_hi v151, v1 offset:3328
    ds_read_u16_d16_hi v152, v1 offset:128
    ds_read_u16_d16_hi v153, v1 offset:384
    ds_read_u16_d16_hi v154, v1 offset:1152
    ds_read_u16_d16_hi v155, v1 offset:1408
    ds_read_u16_d16_hi v156, v1 offset:2176
    ds_read_u16_d16_hi v157, v1 offset:2432
    ds_read_u16_d16_hi v158, v1 offset:3200
    ds_read_u16_d16_hi v159, v1 offset:3456
    ds_read_u16_d16_hi v160, v1 offset:64
    ds_read_u16_d16_hi v161, v1 offset:320
    ds_read_u16_d16_hi v162, v1 offset:1088
    ds_read_u16_d16_hi v163, v1 offset:1344
    ds_read_u16_d16_hi v164, v1 offset:2112
    ds_read_u16_d16_hi v165, v1 offset:2368
    ds_read_u16_d16_hi v166, v1 offset:3136
    ds_read_u16_d16_hi v167, v1 offset:3392
    ds_read_u16_d16_hi v168, v1 offset:192
    ds_read_u16_d16_hi v169, v1 offset:448
    ds_read_u16_d16_hi v170, v1 offset:1216
    ds_read_u16_d16_hi v171, v1 offset:1472
    ds_read_u16_d16_hi v172, v1 offset:2240
    ds_read_u16_d16_hi v173, v1 offset:2496
    ds_read_u16_d16_hi v174, v1 offset:3264
    ds_read_u16_d16_hi v175, v1 offset:3520
    ds_read_b64_tr_b16 v[72:73], v11 offset:0
    ds_read_b64_tr_b16 v[74:75], v11 offset:64
    ds_read_u16 v64, v3 offset:0
    ds_read_u16 v66, v3 offset:4
    ds_read_u16 v68, v3 offset:8
    ds_read_u16 v70, v3 offset:12
    ds_read_u16 v4, v28 offset:48
    s_mov_b32 m0, s62
    s_waitcnt lgkmcnt(0)
    buffer_load_dwordx4 v[64:65], s[48:51], s52 idxen offen offset:0 sc1 lds
    buffer_load_dwordx4 v[66:67], s[48:51], s53 idxen offen offset:1024 sc1 lds
    buffer_load_dwordx4 v[68:69], s[48:51], s54 idxen offen offset:2048 sc1 lds
    buffer_load_dwordx4 v[70:71], s[48:51], s55 idxen offen offset:3072 sc1 lds
    v_exp_f32 v96, v128
    s_setprio 3
    v_mfma_f32_32x32x8_bf16 v[112:127], v[22:23], v[72:73], v[144:159]
    v_exp_f32 v97, v129
    v_rcp_f32 v20, v18
    v_rcp_f32 v21, v19
    v_exp_f32 v98, v130
    v_exp_f32 v99, v131
    v_exp_f32 v100, v132
    v_exp_f32 v101, v133
    v_exp_f32 v102, v134
    v_exp_f32 v103, v135
    v_exp_f32 v104, v136
    v_exp_f32 v105, v137
    v_exp_f32 v106, v138
    v_exp_f32 v107, v139
    v_exp_f32 v108, v140
    v_exp_f32 v109, v141
    v_exp_f32 v110, v142
    v_exp_f32_e64 v111, v143
    v_pk_mul_f32 v[20:21], v[16:17], v[20:21]
    v_pk_add_f32 v[96:97], v[96:97], 1.0 op_sel_hi:[1,0]
    v_pk_add_f32 v[98:99], v[98:99], 1.0 op_sel_hi:[1,0]
    v_pk_add_f32 v[100:101], v[100:101], 1.0 op_sel_hi:[1,0]
    v_pk_add_f32 v[102:103], v[102:103], 1.0 op_sel_hi:[1,0]
    v_pk_add_f32 v[104:105], v[104:105], 1.0 op_sel_hi:[1,0]
    v_pk_add_f32 v[106:107], v[106:107], 1.0 op_sel_hi:[1,0]
    v_pk_add_f32 v[108:109], v[108:109], 1.0 op_sel_hi:[1,0]
    v_pk_add_f32 v[110:111], v[110:111], 1.0 op_sel_hi:[1,0]
    v_cvt_pk_bf16_f32 v89, v20, v21
    v_rcp_f32 v96, v96
    v_rcp_f32 v97, v97
    v_rcp_f32 v98, v98
    v_rcp_f32 v99, v99
    v_rcp_f32 v100, v100
    v_rcp_f32 v101, v101
    v_rcp_f32 v102, v102
    v_rcp_f32 v103, v103
    v_rcp_f32 v104, v104
    v_rcp_f32 v105, v105
    v_rcp_f32 v106, v106
    v_rcp_f32 v107, v107
    v_rcp_f32 v108, v108
    v_rcp_f32 v109, v109
    v_rcp_f32 v110, v110
    v_rcp_f32 v111, v111
    v_pk_mul_f32 v[16:17], v[128:129], v[96:97]
    v_pk_fma_f32 v[16:17], v[130:131], v[98:99], v[16:17]
    v_pk_fma_f32 v[16:17], v[132:133], v[100:101], v[16:17]
    v_pk_fma_f32 v[16:17], v[134:135], v[102:103], v[16:17]
    v_pk_fma_f32 v[16:17], v[136:137], v[104:105], v[16:17]
    v_pk_fma_f32 v[16:17], v[138:139], v[106:107], v[16:17]
    v_pk_fma_f32 v[16:17], v[140:141], v[108:109], v[16:17]
    v_pk_fma_f32 v[16:17], v[142:143], v[110:111], v[16:17]
    v_mfma_f32_32x32x8_bf16 v[128:143], v[22:23], v[74:75], v[160:175]
    v_exp_f32 v96, v112
    v_exp_f32 v97, v113
    v_rcp_f32 v20, v18
    v_rcp_f32 v21, v19
    v_exp_f32 v98, v114
    v_exp_f32 v99, v115
    v_exp_f32 v100, v116
    v_exp_f32 v101, v117
    v_exp_f32 v102, v118
    v_exp_f32 v103, v119
    v_exp_f32 v104, v120
    v_exp_f32 v105, v121
    v_exp_f32 v106, v122
    v_exp_f32 v107, v123
    v_exp_f32 v108, v124
    v_exp_f32 v109, v125
    v_exp_f32 v110, v126
    v_exp_f32 v111, v127
    v_add_u32_e64 v4, v4, v30
    v_pk_mul_f32 v[20:21], v[16:17], v[20:21]
    v_pk_add_f32 v[96:97], v[96:97], 1.0 op_sel_hi:[1,0]
    v_pk_add_f32 v[98:99], v[98:99], 1.0 op_sel_hi:[1,0]
    v_pk_add_f32 v[100:101], v[100:101], 1.0 op_sel_hi:[1,0]
    v_pk_add_f32 v[102:103], v[102:103], 1.0 op_sel_hi:[1,0]
    v_pk_add_f32 v[104:105], v[104:105], 1.0 op_sel_hi:[1,0]
    v_pk_add_f32 v[106:107], v[106:107], 1.0 op_sel_hi:[1,0]
    v_pk_add_f32 v[108:109], v[108:109], 1.0 op_sel_hi:[1,0]
    v_pk_add_f32 v[110:111], v[110:111], 1.0 op_sel_hi:[1,0]
    v_cvt_pk_bf16_f32 v93, v20, v21
    v_rcp_f32 v96, v96
    v_rcp_f32 v97, v97
    v_rcp_f32 v98, v98
    v_rcp_f32 v99, v99
    v_rcp_f32 v100, v100
    v_rcp_f32 v101, v101
    v_rcp_f32 v102, v102
    v_rcp_f32 v103, v103
    v_rcp_f32 v104, v104
    v_rcp_f32 v105, v105
    v_rcp_f32 v106, v106
    v_rcp_f32 v107, v107
    v_rcp_f32 v108, v108
    v_rcp_f32 v109, v109
    v_rcp_f32 v110, v110
    v_rcp_f32 v111, v111
    v_pk_mul_f32 v[16:17], v[112:113], v[96:97]
    v_pk_fma_f32 v[16:17], v[114:115], v[98:99], v[16:17]
    v_pk_fma_f32 v[16:17], v[116:117], v[100:101], v[16:17]
    v_pk_fma_f32 v[16:17], v[118:119], v[102:103], v[16:17]
    v_pk_fma_f32 v[16:17], v[120:121], v[104:105], v[16:17]
    v_pk_fma_f32 v[16:17], v[122:123], v[106:107], v[16:17]
    v_pk_fma_f32 v[16:17], v[124:125], v[108:109], v[16:17]
    v_pk_fma_f32 v[16:17], v[126:127], v[110:111], v[16:17]
SLOTS2:
    s_setprio 0
    s_waitcnt vmcnt(4)
    ds_read_u16_d16_hi v144, v1 offset:4096
    ds_read_u16_d16_hi v145, v1 offset:4352
    ds_read_u16_d16_hi v146, v1 offset:5120
    ds_read_u16_d16_hi v147, v1 offset:5376
    ds_read_u16_d16_hi v148, v1 offset:6144
    ds_read_u16_d16_hi v149, v1 offset:6400
    ds_read_u16_d16_hi v150, v1 offset:7168
    ds_read_u16_d16_hi v151, v1 offset:7424
    ds_read_u16_d16_hi v152, v1 offset:4224
    ds_read_u16_d16_hi v153, v1 offset:4480
    ds_read_u16_d16_hi v154, v1 offset:5248
    ds_read_u16_d16_hi v155, v1 offset:5504
    ds_read_u16_d16_hi v156, v1 offset:6272
    ds_read_u16_d16_hi v157, v1 offset:6528
    ds_read_u16_d16_hi v158, v1 offset:7296
    ds_read_u16_d16_hi v159, v1 offset:7552
    ds_read_u16_d16_hi v160, v1 offset:4160
    ds_read_u16_d16_hi v161, v1 offset:4416
    ds_read_u16_d16_hi v162, v1 offset:5184
    ds_read_u16_d16_hi v163, v1 offset:5440
    ds_read_u16_d16_hi v164, v1 offset:6208
    ds_read_u16_d16_hi v165, v1 offset:6464
    ds_read_u16_d16_hi v166, v1 offset:7232
    ds_read_u16_d16_hi v167, v1 offset:7488
    ds_read_u16_d16_hi v168, v1 offset:4288
    ds_read_u16_d16_hi v169, v1 offset:4544
    ds_read_u16_d16_hi v170, v1 offset:5312
    ds_read_u16_d16_hi v171, v1 offset:5568
    ds_read_u16_d16_hi v172, v1 offset:6336
    ds_read_u16_d16_hi v173, v1 offset:6592
    ds_read_u16_d16_hi v174, v1 offset:7360
    ds_read_u16_d16_hi v175, v1 offset:7616
    ds_read_b64_tr_b16 v[72:73], v11 offset:128
    ds_read_b64_tr_b16 v[74:75], v11 offset:192
    ds_read_u16 v3, v15 offset:64
    ds_read_b32 v26, v4
    ds_read_u16 v10, v5 offset:50
    ds_read_b32 v78, v6 offset:256
    s_mov_b32 m0, s63
    s_cmp_eq_u32 s61, 0
    s_waitcnt lgkmcnt(0)
    s_cbranch_scc1 SKDS2
    buffer_load_dwordx4 v[64:65], s[48:51], s56 idxen offen offset:0 sc1 lds
    buffer_load_dwordx4 v[66:67], s[48:51], s57 idxen offen offset:1024 sc1 lds
    buffer_load_dwordx4 v[68:69], s[48:51], s58 idxen offen offset:2048 sc1 lds
    buffer_load_dwordx4 v[70:71], s[48:51], s59 idxen offen offset:3072 sc1 lds
SKDS2:
    v_exp_f32 v96, v128
    s_setprio 3
    v_mfma_f32_32x32x8_bf16 v[112:127], v[22:23], v[72:73], v[144:159]
    v_exp_f32 v97, v129
    v_rcp_f32 v20, v18
    v_rcp_f32 v21, v19
    v_exp_f32 v98, v130
    v_exp_f32 v99, v131
    v_exp_f32 v100, v132
    v_exp_f32 v101, v133
    v_exp_f32 v102, v134
    v_exp_f32 v103, v135
    v_exp_f32 v104, v136
    v_exp_f32 v105, v137
    v_exp_f32 v106, v138
    v_exp_f32 v107, v139
    v_exp_f32 v108, v140
    v_exp_f32 v109, v141
    v_exp_f32 v110, v142
    v_exp_f32 v111, v143
    v_add_u32 v3, v3, v29
    v_perm_b32 v26, v26, v26, v7
    v_pk_mul_f32 v[20:21], v[16:17], v[20:21]
    v_pk_add_f32 v[96:97], v[96:97], 1.0 op_sel_hi:[1,0]
    v_pk_add_f32 v[98:99], v[98:99], 1.0 op_sel_hi:[1,0]
    v_pk_add_f32 v[100:101], v[100:101], 1.0 op_sel_hi:[1,0]
    v_pk_add_f32 v[102:103], v[102:103], 1.0 op_sel_hi:[1,0]
    v_pk_add_f32 v[104:105], v[104:105], 1.0 op_sel_hi:[1,0]
    v_pk_add_f32 v[106:107], v[106:107], 1.0 op_sel_hi:[1,0]
    v_pk_add_f32 v[108:109], v[108:109], 1.0 op_sel_hi:[1,0]
    v_pk_add_f32 v[110:111], v[110:111], 1.0 op_sel_hi:[1,0]
    v_cvt_pk_bf16_f32 v82, v20, v21
    v_rcp_f32 v96, v96
    v_rcp_f32 v97, v97
    v_rcp_f32 v98, v98
    v_rcp_f32 v99, v99
    v_rcp_f32 v100, v100
    v_rcp_f32 v101, v101
    v_rcp_f32 v102, v102
    v_rcp_f32 v103, v103
    v_rcp_f32 v104, v104
    v_rcp_f32 v105, v105
    v_rcp_f32 v106, v106
    v_rcp_f32 v107, v107
    v_rcp_f32 v108, v108
    v_rcp_f32 v109, v109
    v_rcp_f32 v110, v110
    v_rcp_f32 v111, v111
    v_pk_mul_f32 v[16:17], v[128:129], v[96:97]
    v_pk_fma_f32 v[16:17], v[130:131], v[98:99], v[16:17]
    v_pk_fma_f32 v[16:17], v[132:133], v[100:101], v[16:17]
    v_pk_fma_f32 v[16:17], v[134:135], v[102:103], v[16:17]
    v_pk_fma_f32 v[16:17], v[136:137], v[104:105], v[16:17]
    v_pk_fma_f32 v[16:17], v[138:139], v[106:107], v[16:17]
    v_pk_fma_f32 v[16:17], v[140:141], v[108:109], v[16:17]
    v_pk_fma_f32 v[16:17], v[142:143], v[110:111], v[16:17]
    v_mfma_f32_32x32x8_bf16 v[128:143], v[22:23], v[74:75], v[160:175]
    v_exp_f32 v96, v112
    v_exp_f32 v97, v113
    v_rcp_f32 v20, v18
    v_rcp_f32 v21, v19
    v_exp_f32 v98, v114
    v_exp_f32 v99, v115
    v_exp_f32 v100, v116
    v_exp_f32 v101, v117
    v_exp_f32 v102, v118
    v_exp_f32 v103, v119
    v_exp_f32 v104, v120
    v_exp_f32 v105, v121
    v_exp_f32 v106, v122
    v_exp_f32 v107, v123
    v_exp_f32 v108, v124
    v_exp_f32 v109, v125
    v_exp_f32 v110, v126
    v_exp_f32 v111, v127
    v_mad_u32_u24 v11, v10, v8, v9
    v_pk_mul_f32 v[20:21], v[16:17], v[20:21]
    v_pk_add_f32 v[96:97], v[96:97], 1.0 op_sel_hi:[1,0]
    v_pk_add_f32 v[98:99], v[98:99], 1.0 op_sel_hi:[1,0]
    v_pk_add_f32 v[100:101], v[100:101], 1.0 op_sel_hi:[1,0]
    v_pk_add_f32 v[102:103], v[102:103], 1.0 op_sel_hi:[1,0]
    v_pk_add_f32 v[104:105], v[104:105], 1.0 op_sel_hi:[1,0]
    v_pk_add_f32 v[106:107], v[106:107], 1.0 op_sel_hi:[1,0]
    v_pk_add_f32 v[108:109], v[108:109], 1.0 op_sel_hi:[1,0]
    v_pk_add_f32 v[110:111], v[110:111], 1.0 op_sel_hi:[1,0]
    v_cvt_pk_bf16_f32 v86, v20, v21
    v_pk_fma_f32 v[22:23], v[24:25], v[26:27], v[252:253] op_sel_hi:[1,0,1]
    v_rcp_f32 v96, v96
    v_rcp_f32 v97, v97
    v_rcp_f32 v98, v98
    v_rcp_f32 v99, v99
    v_rcp_f32 v100, v100
    v_rcp_f32 v101, v101
    v_rcp_f32 v102, v102
    v_rcp_f32 v103, v103
    v_rcp_f32 v104, v104
    v_rcp_f32 v105, v105
    v_rcp_f32 v106, v106
    v_rcp_f32 v107, v107
    v_rcp_f32 v108, v108
    v_rcp_f32 v109, v109
    v_rcp_f32 v110, v110
    v_rcp_f32 v111, v111
    v_pk_mul_f32 v[16:17], v[112:113], v[96:97]
    v_pk_fma_f32 v[16:17], v[114:115], v[98:99], v[16:17]
    v_pk_fma_f32 v[16:17], v[116:117], v[100:101], v[16:17]
    v_pk_fma_f32 v[16:17], v[118:119], v[102:103], v[16:17]
    v_pk_fma_f32 v[16:17], v[120:121], v[104:105], v[16:17]
    v_pk_fma_f32 v[16:17], v[122:123], v[106:107], v[16:17]
    v_pk_fma_f32 v[16:17], v[124:125], v[108:109], v[16:17]
    v_pk_fma_f32 v[16:17], v[126:127], v[110:111], v[16:17]
    s_sub_u32 s61, s61, 1
    s_cbranch_scc1 TAILS2
    s_setprio 0
    s_waitcnt vmcnt(4)
    ds_read_u16_d16_hi v144, v1 offset:0
    ds_read_u16_d16_hi v145, v1 offset:256
    ds_read_u16_d16_hi v146, v1 offset:1024
    ds_read_u16_d16_hi v147, v1 offset:1280
    ds_read_u16_d16_hi v148, v1 offset:2048
    ds_read_u16_d16_hi v149, v1 offset:2304
    ds_read_u16_d16_hi v150, v1 offset:3072
    ds_read_u16_d16_hi v151, v1 offset:3328
    ds_read_u16_d16_hi v152, v1 offset:128
    ds_read_u16_d16_hi v153, v1 offset:384
    ds_read_u16_d16_hi v154, v1 offset:1152
    ds_read_u16_d16_hi v155, v1 offset:1408
    ds_read_u16_d16_hi v156, v1 offset:2176
    ds_read_u16_d16_hi v157, v1 offset:2432
    ds_read_u16_d16_hi v158, v1 offset:3200
    ds_read_u16_d16_hi v159, v1 offset:3456
    ds_read_u16_d16_hi v160, v1 offset:64
    ds_read_u16_d16_hi v161, v1 offset:320
    ds_read_u16_d16_hi v162, v1 offset:1088
    ds_read_u16_d16_hi v163, v1 offset:1344
    ds_read_u16_d16_hi v164, v1 offset:2112
    ds_read_u16_d16_hi v165, v1 offset:2368
    ds_read_u16_d16_hi v166, v1 offset:3136
    ds_read_u16_d16_hi v167, v1 offset:3392
    ds_read_u16_d16_hi v168, v1 offset:192
    ds_read_u16_d16_hi v169, v1 offset:448
    ds_read_u16_d16_hi v170, v1 offset:1216
    ds_read_u16_d16_hi v171, v1 offset:1472
    ds_read_u16_d16_hi v172, v1 offset:2240
    ds_read_u16_d16_hi v173, v1 offset:2496
    ds_read_u16_d16_hi v174, v1 offset:3264
    ds_read_u16_d16_hi v175, v1 offset:3520
    ds_read_b64_tr_b16 v[72:73], v11 offset:0
    ds_read_b64_tr_b16 v[74:75], v11 offset:64
    ds_read_u16 v64, v3 offset:0
    ds_read_u16 v66, v3 offset:4
    ds_read_u16 v68, v3 offset:8
    ds_read_u16 v70, v3 offset:12
    ds_read_u16 v4, v28 offset:64
    s_mov_b32 m0, s62
    s_waitcnt lgkmcnt(0)
    buffer_load_dwordx4 v[64:65], s[48:51], s52 idxen offen offset:0 sc1 lds
    buffer_load_dwordx4 v[66:67], s[48:51], s53 idxen offen offset:1024 sc1 lds
    buffer_load_dwordx4 v[68:69], s[48:51], s54 idxen offen offset:2048 sc1 lds
    buffer_load_dwordx4 v[70:71], s[48:51], s55 idxen offen offset:3072 sc1 lds
    v_exp_f32 v96, v128
    s_setprio 3
    v_mfma_f32_32x32x8_bf16 v[112:127], v[22:23], v[72:73], v[144:159]
    v_exp_f32 v97, v129
    v_rcp_f32 v20, v18
    v_rcp_f32 v21, v19
    v_exp_f32 v98, v130
    v_exp_f32 v99, v131
    v_exp_f32 v100, v132
    v_exp_f32 v101, v133
    v_exp_f32 v102, v134
    v_exp_f32 v103, v135
    v_exp_f32 v104, v136
    v_exp_f32 v105, v137
    v_exp_f32 v106, v138
    v_exp_f32 v107, v139
    v_exp_f32 v108, v140
    v_exp_f32 v109, v141
    v_exp_f32 v110, v142
    v_exp_f32_e64 v111, v143
    v_pk_mul_f32 v[20:21], v[16:17], v[20:21]
    v_pk_add_f32 v[96:97], v[96:97], 1.0 op_sel_hi:[1,0]
    v_pk_add_f32 v[98:99], v[98:99], 1.0 op_sel_hi:[1,0]
    v_pk_add_f32 v[100:101], v[100:101], 1.0 op_sel_hi:[1,0]
    v_pk_add_f32 v[102:103], v[102:103], 1.0 op_sel_hi:[1,0]
    v_pk_add_f32 v[104:105], v[104:105], 1.0 op_sel_hi:[1,0]
    v_pk_add_f32 v[106:107], v[106:107], 1.0 op_sel_hi:[1,0]
    v_pk_add_f32 v[108:109], v[108:109], 1.0 op_sel_hi:[1,0]
    v_pk_add_f32 v[110:111], v[110:111], 1.0 op_sel_hi:[1,0]
    v_cvt_pk_bf16_f32 v90, v20, v21
    v_rcp_f32 v96, v96
    v_rcp_f32 v97, v97
    v_rcp_f32 v98, v98
    v_rcp_f32 v99, v99
    v_rcp_f32 v100, v100
    v_rcp_f32 v101, v101
    v_rcp_f32 v102, v102
    v_rcp_f32 v103, v103
    v_rcp_f32 v104, v104
    v_rcp_f32 v105, v105
    v_rcp_f32 v106, v106
    v_rcp_f32 v107, v107
    v_rcp_f32 v108, v108
    v_rcp_f32 v109, v109
    v_rcp_f32 v110, v110
    v_rcp_f32 v111, v111
    v_pk_mul_f32 v[16:17], v[128:129], v[96:97]
    v_pk_fma_f32 v[16:17], v[130:131], v[98:99], v[16:17]
    v_pk_fma_f32 v[16:17], v[132:133], v[100:101], v[16:17]
    v_pk_fma_f32 v[16:17], v[134:135], v[102:103], v[16:17]
    v_pk_fma_f32 v[16:17], v[136:137], v[104:105], v[16:17]
    v_pk_fma_f32 v[16:17], v[138:139], v[106:107], v[16:17]
    v_pk_fma_f32 v[16:17], v[140:141], v[108:109], v[16:17]
    v_pk_fma_f32 v[16:17], v[142:143], v[110:111], v[16:17]
    v_mfma_f32_32x32x8_bf16 v[128:143], v[22:23], v[74:75], v[160:175]
    v_exp_f32 v96, v112
    v_exp_f32 v97, v113
    v_rcp_f32 v20, v18
    v_rcp_f32 v21, v19
    v_exp_f32 v98, v114
    v_exp_f32 v99, v115
    v_exp_f32 v100, v116
    v_exp_f32 v101, v117
    v_exp_f32 v102, v118
    v_exp_f32 v103, v119
    v_exp_f32 v104, v120
    v_exp_f32 v105, v121
    v_exp_f32 v106, v122
    v_exp_f32 v107, v123
    v_exp_f32 v108, v124
    v_exp_f32 v109, v125
    v_exp_f32 v110, v126
    v_exp_f32 v111, v127
    v_add_u32_e64 v4, v4, v30
    v_pk_mul_f32 v[20:21], v[16:17], v[20:21]
    v_pk_add_f32 v[96:97], v[96:97], 1.0 op_sel_hi:[1,0]
    v_pk_add_f32 v[98:99], v[98:99], 1.0 op_sel_hi:[1,0]
    v_pk_add_f32 v[100:101], v[100:101], 1.0 op_sel_hi:[1,0]
    v_pk_add_f32 v[102:103], v[102:103], 1.0 op_sel_hi:[1,0]
    v_pk_add_f32 v[104:105], v[104:105], 1.0 op_sel_hi:[1,0]
    v_pk_add_f32 v[106:107], v[106:107], 1.0 op_sel_hi:[1,0]
    v_pk_add_f32 v[108:109], v[108:109], 1.0 op_sel_hi:[1,0]
    v_pk_add_f32 v[110:111], v[110:111], 1.0 op_sel_hi:[1,0]
    v_cvt_pk_bf16_f32 v94, v20, v21
    v_rcp_f32 v96, v96
    v_rcp_f32 v97, v97
    v_rcp_f32 v98, v98
    v_rcp_f32 v99, v99
    v_rcp_f32 v100, v100
    v_rcp_f32 v101, v101
    v_rcp_f32 v102, v102
    v_rcp_f32 v103, v103
    v_rcp_f32 v104, v104
    v_rcp_f32 v105, v105
    v_rcp_f32 v106, v106
    v_rcp_f32 v107, v107
    v_rcp_f32 v108, v108
    v_rcp_f32 v109, v109
    v_rcp_f32 v110, v110
    v_rcp_f32 v111, v111
    v_pk_mul_f32 v[16:17], v[112:113], v[96:97]
    v_pk_fma_f32 v[16:17], v[114:115], v[98:99], v[16:17]
    v_pk_fma_f32 v[16:17], v[116:117], v[100:101], v[16:17]
    v_pk_fma_f32 v[16:17], v[118:119], v[102:103], v[16:17]
    v_pk_fma_f32 v[16:17], v[120:121], v[104:105], v[16:17]
    v_pk_fma_f32 v[16:17], v[122:123], v[106:107], v[16:17]
    v_pk_fma_f32 v[16:17], v[124:125], v[108:109], v[16:17]
    v_pk_fma_f32 v[16:17], v[126:127], v[110:111], v[16:17]
SLOTS3:
    s_setprio 0
    s_waitcnt vmcnt(4)
    ds_read_u16_d16_hi v144, v1 offset:4096
    ds_read_u16_d16_hi v145, v1 offset:4352
    ds_read_u16_d16_hi v146, v1 offset:5120
    ds_read_u16_d16_hi v147, v1 offset:5376
    ds_read_u16_d16_hi v148, v1 offset:6144
    ds_read_u16_d16_hi v149, v1 offset:6400
    ds_read_u16_d16_hi v150, v1 offset:7168
    ds_read_u16_d16_hi v151, v1 offset:7424
    ds_read_u16_d16_hi v152, v1 offset:4224
    ds_read_u16_d16_hi v153, v1 offset:4480
    ds_read_u16_d16_hi v154, v1 offset:5248
    ds_read_u16_d16_hi v155, v1 offset:5504
    ds_read_u16_d16_hi v156, v1 offset:6272
    ds_read_u16_d16_hi v157, v1 offset:6528
    ds_read_u16_d16_hi v158, v1 offset:7296
    ds_read_u16_d16_hi v159, v1 offset:7552
    ds_read_u16_d16_hi v160, v1 offset:4160
    ds_read_u16_d16_hi v161, v1 offset:4416
    ds_read_u16_d16_hi v162, v1 offset:5184
    ds_read_u16_d16_hi v163, v1 offset:5440
    ds_read_u16_d16_hi v164, v1 offset:6208
    ds_read_u16_d16_hi v165, v1 offset:6464
    ds_read_u16_d16_hi v166, v1 offset:7232
    ds_read_u16_d16_hi v167, v1 offset:7488
    ds_read_u16_d16_hi v168, v1 offset:4288
    ds_read_u16_d16_hi v169, v1 offset:4544
    ds_read_u16_d16_hi v170, v1 offset:5312
    ds_read_u16_d16_hi v171, v1 offset:5568
    ds_read_u16_d16_hi v172, v1 offset:6336
    ds_read_u16_d16_hi v173, v1 offset:6592
    ds_read_u16_d16_hi v174, v1 offset:7360
    ds_read_u16_d16_hi v175, v1 offset:7616
    ds_read_b64_tr_b16 v[72:73], v11 offset:128
    ds_read_b64_tr_b16 v[74:75], v11 offset:192
    ds_read_u16 v3, v15 offset:80
    ds_read_b32 v26, v4
    ds_read_u16 v10, v5 offset:66
    ds_read_b32 v79, v6 offset:384
    s_mov_b32 m0, s63
    s_cmp_eq_u32 s61, 0
    s_waitcnt lgkmcnt(0)
    s_cbranch_scc1 SKDS3
    buffer_load_dwordx4 v[64:65], s[48:51], s56 idxen offen offset:0 sc1 lds
    buffer_load_dwordx4 v[66:67], s[48:51], s57 idxen offen offset:1024 sc1 lds
    buffer_load_dwordx4 v[68:69], s[48:51], s58 idxen offen offset:2048 sc1 lds
    buffer_load_dwordx4 v[70:71], s[48:51], s59 idxen offen offset:3072 sc1 lds
SKDS3:
    v_exp_f32 v96, v128
    s_setprio 3
    v_mfma_f32_32x32x8_bf16 v[112:127], v[22:23], v[72:73], v[144:159]
    v_exp_f32 v97, v129
    v_rcp_f32 v20, v18
    v_rcp_f32 v21, v19
    v_exp_f32 v98, v130
    v_exp_f32 v99, v131
    v_exp_f32 v100, v132
    v_exp_f32 v101, v133
    v_exp_f32 v102, v134
    v_exp_f32 v103, v135
    v_exp_f32 v104, v136
    v_exp_f32 v105, v137
    v_exp_f32 v106, v138
    v_exp_f32 v107, v139
    v_exp_f32 v108, v140
    v_exp_f32 v109, v141
    v_exp_f32 v110, v142
    v_exp_f32 v111, v143
    v_add_u32 v3, v3, v29
    v_perm_b32 v26, v26, v26, v7
    v_pk_mul_f32 v[20:21], v[16:17], v[20:21]
    v_pk_add_f32 v[96:97], v[96:97], 1.0 op_sel_hi:[1,0]
    v_pk_add_f32 v[98:99], v[98:99], 1.0 op_sel_hi:[1,0]
    v_pk_add_f32 v[100:101], v[100:101], 1.0 op_sel_hi:[1,0]
    v_pk_add_f32 v[102:103], v[102:103], 1.0 op_sel_hi:[1,0]
    v_pk_add_f32 v[104:105], v[104:105], 1.0 op_sel_hi:[1,0]
    v_pk_add_f32 v[106:107], v[106:107], 1.0 op_sel_hi:[1,0]
    v_pk_add_f32 v[108:109], v[108:109], 1.0 op_sel_hi:[1,0]
    v_pk_add_f32 v[110:111], v[110:111], 1.0 op_sel_hi:[1,0]
    v_cvt_pk_bf16_f32 v83, v20, v21
    v_rcp_f32 v96, v96
    v_rcp_f32 v97, v97
    v_rcp_f32 v98, v98
    v_rcp_f32 v99, v99
    v_rcp_f32 v100, v100
    v_rcp_f32 v101, v101
    v_rcp_f32 v102, v102
    v_rcp_f32 v103, v103
    v_rcp_f32 v104, v104
    v_rcp_f32 v105, v105
    v_rcp_f32 v106, v106
    v_rcp_f32 v107, v107
    v_rcp_f32 v108, v108
    v_rcp_f32 v109, v109
    v_rcp_f32 v110, v110
    v_rcp_f32 v111, v111
    v_pk_mul_f32 v[16:17], v[128:129], v[96:97]
    v_pk_fma_f32 v[16:17], v[130:131], v[98:99], v[16:17]
    v_pk_fma_f32 v[16:17], v[132:133], v[100:101], v[16:17]
    v_pk_fma_f32 v[16:17], v[134:135], v[102:103], v[16:17]
    v_pk_fma_f32 v[16:17], v[136:137], v[104:105], v[16:17]
    v_pk_fma_f32 v[16:17], v[138:139], v[106:107], v[16:17]
    v_pk_fma_f32 v[16:17], v[140:141], v[108:109], v[16:17]
    v_pk_fma_f32 v[16:17], v[142:143], v[110:111], v[16:17]
    v_mfma_f32_32x32x8_bf16 v[128:143], v[22:23], v[74:75], v[160:175]
    v_exp_f32 v96, v112
    v_exp_f32 v97, v113
    v_rcp_f32 v20, v18
    v_rcp_f32 v21, v19
    v_exp_f32 v98, v114
    v_exp_f32 v99, v115
    v_exp_f32 v100, v116
    v_exp_f32 v101, v117
    v_exp_f32 v102, v118
    v_exp_f32 v103, v119
    v_exp_f32 v104, v120
    v_exp_f32 v105, v121
    v_exp_f32 v106, v122
    v_exp_f32 v107, v123
    v_exp_f32 v108, v124
    v_exp_f32 v109, v125
    v_exp_f32 v110, v126
    v_exp_f32 v111, v127
    v_mad_u32_u24 v11, v10, v8, v9
    v_add_u32 v15, 64, v15
    v_add_u32 v28, 64, v28
    v_add_u32_e64 v5, 64, v5
    v_add_u32 v6, 512, v6
    v_pk_mul_f32 v[20:21], v[16:17], v[20:21]
    v_pk_add_f32 v[96:97], v[96:97], 1.0 op_sel_hi:[1,0]
    v_pk_add_f32 v[98:99], v[98:99], 1.0 op_sel_hi:[1,0]
    v_pk_add_f32 v[100:101], v[100:101], 1.0 op_sel_hi:[1,0]
    v_pk_add_f32 v[102:103], v[102:103], 1.0 op_sel_hi:[1,0]
    v_pk_add_f32 v[104:105], v[104:105], 1.0 op_sel_hi:[1,0]
    v_pk_add_f32 v[106:107], v[106:107], 1.0 op_sel_hi:[1,0]
    v_pk_add_f32 v[108:109], v[108:109], 1.0 op_sel_hi:[1,0]
    v_pk_add_f32 v[110:111], v[110:111], 1.0 op_sel_hi:[1,0]
    v_cvt_pk_bf16_f32 v87, v20, v21
    v_pk_fma_f32 v[22:23], v[24:25], v[26:27], v[252:253] op_sel_hi:[1,0,1]
    v_rcp_f32 v96, v96
    v_rcp_f32 v97, v97
    v_rcp_f32 v98, v98
    v_rcp_f32 v99, v99
    v_rcp_f32 v100, v100
    v_rcp_f32 v101, v101
    v_rcp_f32 v102, v102
    v_rcp_f32 v103, v103
    v_rcp_f32 v104, v104
    v_rcp_f32 v105, v105
    v_rcp_f32 v106, v106
    v_rcp_f32 v107, v107
    v_rcp_f32 v108, v108
    v_rcp_f32 v109, v109
    v_rcp_f32 v110, v110
    v_rcp_f32 v111, v111
    v_pk_mul_f32 v[16:17], v[112:113], v[96:97]
    v_pk_fma_f32 v[16:17], v[114:115], v[98:99], v[16:17]
    v_pk_fma_f32 v[16:17], v[116:117], v[100:101], v[16:17]
    v_pk_fma_f32 v[16:17], v[118:119], v[102:103], v[16:17]
    v_pk_fma_f32 v[16:17], v[120:121], v[104:105], v[16:17]
    v_pk_fma_f32 v[16:17], v[122:123], v[106:107], v[16:17]
    v_pk_fma_f32 v[16:17], v[124:125], v[108:109], v[16:17]
    v_pk_fma_f32 v[16:17], v[126:127], v[110:111], v[16:17]
    s_sub_u32 s61, s61, 1
    s_cbranch_scc1 TAILS3
    s_setprio 0
    s_waitcnt vmcnt(4)
    ds_read_u16_d16_hi v144, v1 offset:0
    ds_read_u16_d16_hi v145, v1 offset:256
    ds_read_u16_d16_hi v146, v1 offset:1024
    ds_read_u16_d16_hi v147, v1 offset:1280
    ds_read_u16_d16_hi v148, v1 offset:2048
    ds_read_u16_d16_hi v149, v1 offset:2304
    ds_read_u16_d16_hi v150, v1 offset:3072
    ds_read_u16_d16_hi v151, v1 offset:3328
    ds_read_u16_d16_hi v152, v1 offset:128
    ds_read_u16_d16_hi v153, v1 offset:384
    ds_read_u16_d16_hi v154, v1 offset:1152
    ds_read_u16_d16_hi v155, v1 offset:1408
    ds_read_u16_d16_hi v156, v1 offset:2176
    ds_read_u16_d16_hi v157, v1 offset:2432
    ds_read_u16_d16_hi v158, v1 offset:3200
    ds_read_u16_d16_hi v159, v1 offset:3456
    ds_read_u16_d16_hi v160, v1 offset:64
    ds_read_u16_d16_hi v161, v1 offset:320
    ds_read_u16_d16_hi v162, v1 offset:1088
    ds_read_u16_d16_hi v163, v1 offset:1344
    ds_read_u16_d16_hi v164, v1 offset:2112
    ds_read_u16_d16_hi v165, v1 offset:2368
    ds_read_u16_d16_hi v166, v1 offset:3136
    ds_read_u16_d16_hi v167, v1 offset:3392
    ds_read_u16_d16_hi v168, v1 offset:192
    ds_read_u16_d16_hi v169, v1 offset:448
    ds_read_u16_d16_hi v170, v1 offset:1216
    ds_read_u16_d16_hi v171, v1 offset:1472
    ds_read_u16_d16_hi v172, v1 offset:2240
    ds_read_u16_d16_hi v173, v1 offset:2496
    ds_read_u16_d16_hi v174, v1 offset:3264
    ds_read_u16_d16_hi v175, v1 offset:3520
    ds_read_b64_tr_b16 v[72:73], v11 offset:0
    ds_read_b64_tr_b16 v[74:75], v11 offset:64
    ds_read_u16 v64, v3 offset:0
    ds_read_u16 v66, v3 offset:4
    ds_read_u16 v68, v3 offset:8
    ds_read_u16 v70, v3 offset:12
    ds_read_u16 v4, v28 offset:16
    s_mov_b32 m0, s62
    s_waitcnt lgkmcnt(0)
    buffer_load_dwordx4 v[64:65], s[48:51], s52 idxen offen offset:0 sc1 lds
    buffer_load_dwordx4 v[66:67], s[48:51], s53 idxen offen offset:1024 sc1 lds
    buffer_load_dwordx4 v[68:69], s[48:51], s54 idxen offen offset:2048 sc1 lds
    buffer_load_dwordx4 v[70:71], s[48:51], s55 idxen offen offset:3072 sc1 lds
    v_exp_f32 v96, v128
    v_exp_f32 v97, v129
    v_mfma_f32_32x32x16_bf16 v[176:191], v[80:83], v[76:79], v[176:191]
    s_setprio 3
    v_rcp_f32 v20, v18
    v_rcp_f32 v21, v19
    v_exp_f32 v98, v130
    v_mfma_f32_32x32x8_bf16 v[112:127], v[22:23], v[72:73], v[144:159]
    v_exp_f32 v99, v131
    v_exp_f32 v100, v132
    v_exp_f32 v101, v133
    v_exp_f32 v102, v134
    v_exp_f32 v103, v135
    v_exp_f32 v104, v136
    v_exp_f32 v105, v137
    v_exp_f32 v106, v138
    v_exp_f32 v107, v139
    v_exp_f32 v108, v140
    v_exp_f32 v109, v141
    v_exp_f32 v110, v142
    v_exp_f32_e64 v111, v143
    v_pk_mul_f32 v[20:21], v[16:17], v[20:21]
    v_pk_add_f32 v[96:97], v[96:97], 1.0 op_sel_hi:[1,0]
    v_pk_add_f32 v[98:99], v[98:99], 1.0 op_sel_hi:[1,0]
    v_pk_add_f32 v[100:101], v[100:101], 1.0 op_sel_hi:[1,0]
    v_pk_add_f32 v[102:103], v[102:103], 1.0 op_sel_hi:[1,0]
    v_pk_add_f32 v[104:105], v[104:105], 1.0 op_sel_hi:[1,0]
    v_pk_add_f32 v[106:107], v[106:107], 1.0 op_sel_hi:[1,0]
    v_pk_add_f32 v[108:109], v[108:109], 1.0 op_sel_hi:[1,0]
    v_pk_add_f32 v[110:111], v[110:111], 1.0 op_sel_hi:[1,0]
    v_cvt_pk_bf16_f32 v91, v20, v21
    v_rcp_f32 v96, v96
    v_rcp_f32 v97, v97
    v_rcp_f32 v98, v98
    v_rcp_f32 v99, v99
    v_rcp_f32 v100, v100
    v_rcp_f32 v101, v101
    v_rcp_f32 v102, v102
    v_rcp_f32 v103, v103
    v_rcp_f32 v104, v104
    v_rcp_f32 v105, v105
    v_rcp_f32 v106, v106
    v_rcp_f32 v107, v107
    v_rcp_f32 v108, v108
    v_rcp_f32 v109, v109
    v_rcp_f32 v110, v110
    v_rcp_f32 v111, v111
    v_pk_mul_f32 v[16:17], v[128:129], v[96:97]
    v_pk_fma_f32 v[16:17], v[130:131], v[98:99], v[16:17]
    v_pk_fma_f32 v[16:17], v[132:133], v[100:101], v[16:17]
    v_pk_fma_f32 v[16:17], v[134:135], v[102:103], v[16:17]
    v_pk_fma_f32 v[16:17], v[136:137], v[104:105], v[16:17]
    v_pk_fma_f32 v[16:17], v[138:139], v[106:107], v[16:17]
    v_pk_fma_f32 v[16:17], v[140:141], v[108:109], v[16:17]
    v_pk_fma_f32 v[16:17], v[142:143], v[110:111], v[16:17]
    v_mfma_f32_32x32x8_bf16 v[128:143], v[22:23], v[74:75], v[160:175]
    v_exp_f32 v96, v112
    v_exp_f32 v97, v113
    v_rcp_f32 v20, v18
    v_rcp_f32 v21, v19
    v_exp_f32 v98, v114
    v_exp_f32 v99, v115
    v_exp_f32 v100, v116
    v_exp_f32 v101, v117
    v_exp_f32 v102, v118
    v_exp_f32 v103, v119
    v_exp_f32 v104, v120
    v_exp_f32 v105, v121
    v_exp_f32 v106, v122
    v_exp_f32 v107, v123
    v_exp_f32 v108, v124
    v_exp_f32 v109, v125
    v_exp_f32 v110, v126
    v_exp_f32 v111, v127
    v_add_u32_e64 v4, v4, v30
    v_pk_mul_f32 v[20:21], v[16:17], v[20:21]
    v_pk_add_f32 v[96:97], v[96:97], 1.0 op_sel_hi:[1,0]
    v_pk_add_f32 v[98:99], v[98:99], 1.0 op_sel_hi:[1,0]
    v_pk_add_f32 v[100:101], v[100:101], 1.0 op_sel_hi:[1,0]
    v_pk_add_f32 v[102:103], v[102:103], 1.0 op_sel_hi:[1,0]
    v_pk_add_f32 v[104:105], v[104:105], 1.0 op_sel_hi:[1,0]
    v_pk_add_f32 v[106:107], v[106:107], 1.0 op_sel_hi:[1,0]
    v_pk_add_f32 v[108:109], v[108:109], 1.0 op_sel_hi:[1,0]
    v_pk_add_f32 v[110:111], v[110:111], 1.0 op_sel_hi:[1,0]
    v_cvt_pk_bf16_f32 v95, v20, v21
    v_rcp_f32 v96, v96
    v_rcp_f32 v97, v97
    v_rcp_f32 v98, v98
    v_rcp_f32 v99, v99
    v_rcp_f32 v100, v100
    v_rcp_f32 v101, v101
    v_rcp_f32 v102, v102
    v_rcp_f32 v103, v103
    v_rcp_f32 v104, v104
    v_rcp_f32 v105, v105
    v_rcp_f32 v106, v106
    v_rcp_f32 v107, v107
    v_rcp_f32 v108, v108
    v_rcp_f32 v109, v109
    v_rcp_f32 v110, v110
    v_rcp_f32 v111, v111
    v_pk_mul_f32 v[16:17], v[112:113], v[96:97]
    v_pk_fma_f32 v[16:17], v[114:115], v[98:99], v[16:17]
    v_pk_fma_f32 v[16:17], v[116:117], v[100:101], v[16:17]
    v_pk_fma_f32 v[16:17], v[118:119], v[102:103], v[16:17]
    v_pk_fma_f32 v[16:17], v[120:121], v[104:105], v[16:17]
    v_pk_fma_f32 v[16:17], v[122:123], v[106:107], v[16:17]
    v_pk_fma_f32 v[16:17], v[124:125], v[108:109], v[16:17]
    v_pk_fma_f32 v[16:17], v[126:127], v[110:111], v[16:17]
    s_branch LOOPS
    s_nop 0
TAILS2:
    s_setprio 0
    s_nop 0
    ds_read_b64_tr_b16 v[32:33], v246 offset:0
    ds_read_b64_tr_b16 v[34:35], v246 offset:1024
    ds_read_b64_tr_b16 v[36:37], v246 offset:32
    ds_read_b64_tr_b16 v[38:39], v246 offset:1056
    ds_read_b64_tr_b16 v[40:41], v27 offset:0
    ds_read_b64_tr_b16 v[42:43], v27 offset:1024
    ds_read_b64_tr_b16 v[44:45], v27 offset:32
    ds_read_b64_tr_b16 v[46:47], v27 offset:1056
    ds_read_b64_tr_b16 v[48:49], v246 offset:4096
    ds_read_b64_tr_b16 v[50:51], v246 offset:5120
    ds_read_b64_tr_b16 v[52:53], v246 offset:4128
    ds_read_b64_tr_b16 v[54:55], v246 offset:5152
    ds_read_b64_tr_b16 v[56:57], v27 offset:4096
    ds_read_b64_tr_b16 v[58:59], v27 offset:5120
    ds_read_b64_tr_b16 v[60:61], v27 offset:4128
    ds_read_b64_tr_b16 v[62:63], v27 offset:5152
    ds_read_b64_tr_b16 v[144:145], v246 offset:8192
    ds_read_b64_tr_b16 v[146:147], v246 offset:9216
    ds_read_b64_tr_b16 v[148:149], v246 offset:8224
    ds_read_b64_tr_b16 v[150:151], v246 offset:9248
    ds_read_b64_tr_b16 v[152:153], v27 offset:8192
    ds_read_b64_tr_b16 v[154:155], v27 offset:9216
    ds_read_b64_tr_b16 v[156:157], v27 offset:8224
    ds_read_b64_tr_b16 v[158:159], v27 offset:9248
    ds_read_b64_tr_b16 v[160:161], v246 offset:12288
    ds_read_b64_tr_b16 v[162:163], v246 offset:13312
    ds_read_b64_tr_b16 v[164:165], v246 offset:12320
    ds_read_b64_tr_b16 v[166:167], v246 offset:13344
    ds_read_b64_tr_b16 v[168:169], v27 offset:12288
    ds_read_b64_tr_b16 v[170:171], v27 offset:13312
    ds_read_b64_tr_b16 v[172:173], v27 offset:12320
    ds_read_b64_tr_b16 v[174:175], v27 offset:13344
    v_exp_f32 v96, v128
    s_setprio 3
    v_exp_f32 v97, v129
    v_rcp_f32 v20, v18
    v_rcp_f32 v21, v19
    v_exp_f32 v98, v130
    v_exp_f32 v99, v131
    v_exp_f32 v100, v132
    v_exp_f32 v101, v133
    v_exp_f32 v102, v134
    v_exp_f32 v103, v135
    v_exp_f32 v104, v136
    v_exp_f32 v105, v137
    v_exp_f32 v106, v138
    v_exp_f32 v107, v139
    v_exp_f32 v108, v140
    v_exp_f32 v109, v141
    v_exp_f32 v110, v142
    v_exp_f32_e64 v111, v143
    v_pk_mul_f32 v[20:21], v[16:17], v[20:21]
    v_pk_add_f32 v[96:97], v[96:97], 1.0 op_sel_hi:[1,0]
    v_pk_add_f32 v[98:99], v[98:99], 1.0 op_sel_hi:[1,0]
    v_pk_add_f32 v[100:101], v[100:101], 1.0 op_sel_hi:[1,0]
    v_pk_add_f32 v[102:103], v[102:103], 1.0 op_sel_hi:[1,0]
    v_pk_add_f32 v[104:105], v[104:105], 1.0 op_sel_hi:[1,0]
    v_pk_add_f32 v[106:107], v[106:107], 1.0 op_sel_hi:[1,0]
    v_pk_add_f32 v[108:109], v[108:109], 1.0 op_sel_hi:[1,0]
    v_pk_add_f32 v[110:111], v[110:111], 1.0 op_sel_hi:[1,0]
    v_cvt_pk_bf16_f32 v90, v20, v21
    v_rcp_f32 v96, v96
    v_rcp_f32 v97, v97
    v_rcp_f32 v98, v98
    v_rcp_f32 v99, v99
    v_rcp_f32 v100, v100
    v_rcp_f32 v101, v101
    v_rcp_f32 v102, v102
    v_rcp_f32 v103, v103
    v_rcp_f32 v104, v104
    v_rcp_f32 v105, v105
    v_rcp_f32 v106, v106
    v_rcp_f32 v107, v107
    v_rcp_f32 v108, v108
    v_rcp_f32 v109, v109
    v_rcp_f32 v110, v110
    v_rcp_f32 v111, v111
    v_pk_mul_f32 v[16:17], v[128:129], v[96:97]
    v_pk_fma_f32 v[16:17], v[130:131], v[98:99], v[16:17]
    v_pk_fma_f32 v[16:17], v[132:133], v[100:101], v[16:17]
    v_pk_fma_f32 v[16:17], v[134:135], v[102:103], v[16:17]
    v_pk_fma_f32 v[16:17], v[136:137], v[104:105], v[16:17]
    v_pk_fma_f32 v[16:17], v[138:139], v[106:107], v[16:17]
    v_pk_fma_f32 v[16:17], v[140:141], v[108:109], v[16:17]
    v_pk_fma_f32 v[16:17], v[142:143], v[110:111], v[16:17]
    v_rcp_f32 v20, v18
    v_rcp_f32 v21, v19
    v_mov_b32_e64 v79, 0
    v_pk_mul_f32 v[20:21], v[16:17], v[20:21]
    v_cvt_pk_bf16_f32 v94, v20, v21
    s_nop 0
    s_branch DRAIN
TAILS3:
    s_setprio 0
    s_nop 0
    ds_read_b64_tr_b16 v[32:33], v246 offset:0
    ds_read_b64_tr_b16 v[34:35], v246 offset:1024
    ds_read_b64_tr_b16 v[36:37], v246 offset:32
    ds_read_b64_tr_b16 v[38:39], v246 offset:1056
    ds_read_b64_tr_b16 v[40:41], v27 offset:0
    ds_read_b64_tr_b16 v[42:43], v27 offset:1024
    ds_read_b64_tr_b16 v[44:45], v27 offset:32
    ds_read_b64_tr_b16 v[46:47], v27 offset:1056
    ds_read_b64_tr_b16 v[48:49], v246 offset:4096
    ds_read_b64_tr_b16 v[50:51], v246 offset:5120
    ds_read_b64_tr_b16 v[52:53], v246 offset:4128
    ds_read_b64_tr_b16 v[54:55], v246 offset:5152
    ds_read_b64_tr_b16 v[56:57], v27 offset:4096
    ds_read_b64_tr_b16 v[58:59], v27 offset:5120
    ds_read_b64_tr_b16 v[60:61], v27 offset:4128
    ds_read_b64_tr_b16 v[62:63], v27 offset:5152
    ds_read_b64_tr_b16 v[144:145], v246 offset:8192
    ds_read_b64_tr_b16 v[146:147], v246 offset:9216
    ds_read_b64_tr_b16 v[148:149], v246 offset:8224
    ds_read_b64_tr_b16 v[150:151], v246 offset:9248
    ds_read_b64_tr_b16 v[152:153], v27 offset:8192
    ds_read_b64_tr_b16 v[154:155], v27 offset:9216
    ds_read_b64_tr_b16 v[156:157], v27 offset:8224
    ds_read_b64_tr_b16 v[158:159], v27 offset:9248
    ds_read_b64_tr_b16 v[160:161], v246 offset:12288
    ds_read_b64_tr_b16 v[162:163], v246 offset:13312
    ds_read_b64_tr_b16 v[164:165], v246 offset:12320
    ds_read_b64_tr_b16 v[166:167], v246 offset:13344
    ds_read_b64_tr_b16 v[168:169], v27 offset:12288
    ds_read_b64_tr_b16 v[170:171], v27 offset:13312
    ds_read_b64_tr_b16 v[172:173], v27 offset:12320
    ds_read_b64_tr_b16 v[174:175], v27 offset:13344
    v_exp_f32 v96, v128
    s_setprio 3
    v_exp_f32 v97, v129
    v_rcp_f32 v20, v18
    v_rcp_f32 v21, v19
    v_exp_f32 v98, v130
    v_exp_f32 v99, v131
    v_exp_f32 v100, v132
    v_exp_f32 v101, v133
    v_exp_f32 v102, v134
    v_exp_f32 v103, v135
    v_exp_f32 v104, v136
    v_exp_f32 v105, v137
    v_exp_f32 v106, v138
    v_exp_f32 v107, v139
    v_exp_f32 v108, v140
    v_exp_f32 v109, v141
    v_exp_f32 v110, v142
    v_exp_f32_e64 v111, v143
    v_pk_mul_f32 v[20:21], v[16:17], v[20:21]
    v_pk_add_f32 v[96:97], v[96:97], 1.0 op_sel_hi:[1,0]
    v_pk_add_f32 v[98:99], v[98:99], 1.0 op_sel_hi:[1,0]
    v_pk_add_f32 v[100:101], v[100:101], 1.0 op_sel_hi:[1,0]
    v_pk_add_f32 v[102:103], v[102:103], 1.0 op_sel_hi:[1,0]
    v_pk_add_f32 v[104:105], v[104:105], 1.0 op_sel_hi:[1,0]
    v_pk_add_f32 v[106:107], v[106:107], 1.0 op_sel_hi:[1,0]
    v_pk_add_f32 v[108:109], v[108:109], 1.0 op_sel_hi:[1,0]
    v_pk_add_f32 v[110:111], v[110:111], 1.0 op_sel_hi:[1,0]
    v_cvt_pk_bf16_f32 v91, v20, v21
    v_rcp_f32 v96, v96
    v_rcp_f32 v97, v97
    v_rcp_f32 v98, v98
    v_rcp_f32 v99, v99
    v_rcp_f32 v100, v100
    v_rcp_f32 v101, v101
    v_rcp_f32 v102, v102
    v_rcp_f32 v103, v103
    v_rcp_f32 v104, v104
    v_rcp_f32 v105, v105
    v_rcp_f32 v106, v106
    v_rcp_f32 v107, v107
    v_rcp_f32 v108, v108
    v_rcp_f32 v109, v109
    v_rcp_f32 v110, v110
    v_rcp_f32 v111, v111
    v_pk_mul_f32 v[16:17], v[128:129], v[96:97]
    v_pk_fma_f32 v[16:17], v[130:131], v[98:99], v[16:17]
    v_pk_fma_f32 v[16:17], v[132:133], v[100:101], v[16:17]
    v_pk_fma_f32 v[16:17], v[134:135], v[102:103], v[16:17]
    v_pk_fma_f32 v[16:17], v[136:137], v[104:105], v[16:17]
    v_pk_fma_f32 v[16:17], v[138:139], v[106:107], v[16:17]
    v_pk_fma_f32 v[16:17], v[140:141], v[108:109], v[16:17]
    v_pk_fma_f32 v[16:17], v[142:143], v[110:111], v[16:17]
    v_rcp_f32 v20, v18
    v_rcp_f32 v21, v19
    v_mov_b32_e64 v31, 0
    v_pk_mul_f32 v[20:21], v[16:17], v[20:21]
    v_cvt_pk_bf16_f32 v95, v20, v21
    s_nop 0
    s_branch DRAIN
TAILS0:
    s_setprio 0
    s_nop 0
    ds_read_b64_tr_b16 v[32:33], v246 offset:0
    ds_read_b64_tr_b16 v[34:35], v246 offset:1024
    ds_read_b64_tr_b16 v[36:37], v246 offset:32
    ds_read_b64_tr_b16 v[38:39], v246 offset:1056
    ds_read_b64_tr_b16 v[40:41], v27 offset:0
    ds_read_b64_tr_b16 v[42:43], v27 offset:1024
    ds_read_b64_tr_b16 v[44:45], v27 offset:32
    ds_read_b64_tr_b16 v[46:47], v27 offset:1056
    ds_read_b64_tr_b16 v[48:49], v246 offset:4096
    ds_read_b64_tr_b16 v[50:51], v246 offset:5120
    ds_read_b64_tr_b16 v[52:53], v246 offset:4128
    ds_read_b64_tr_b16 v[54:55], v246 offset:5152
    ds_read_b64_tr_b16 v[56:57], v27 offset:4096
    ds_read_b64_tr_b16 v[58:59], v27 offset:5120
    ds_read_b64_tr_b16 v[60:61], v27 offset:4128
    ds_read_b64_tr_b16 v[62:63], v27 offset:5152
    ds_read_b64_tr_b16 v[144:145], v246 offset:8192
    ds_read_b64_tr_b16 v[146:147], v246 offset:9216
    ds_read_b64_tr_b16 v[148:149], v246 offset:8224
    ds_read_b64_tr_b16 v[150:151], v246 offset:9248
    ds_read_b64_tr_b16 v[152:153], v27 offset:8192
    ds_read_b64_tr_b16 v[154:155], v27 offset:9216
    ds_read_b64_tr_b16 v[156:157], v27 offset:8224
    ds_read_b64_tr_b16 v[158:159], v27 offset:9248
    ds_read_b64_tr_b16 v[160:161], v246 offset:12288
    ds_read_b64_tr_b16 v[162:163], v246 offset:13312
    ds_read_b64_tr_b16 v[164:165], v246 offset:12320
    ds_read_b64_tr_b16 v[166:167], v246 offset:13344
    ds_read_b64_tr_b16 v[168:169], v27 offset:12288
    ds_read_b64_tr_b16 v[170:171], v27 offset:13312
    ds_read_b64_tr_b16 v[172:173], v27 offset:12320
    ds_read_b64_tr_b16 v[174:175], v27 offset:13344
    v_exp_f32 v96, v128
    v_exp_f32 v97, v129
    v_mfma_f32_32x32x16_bf16 v[224:239], v[92:95], v[76:79], v[224:239]
    s_setprio 3
    v_rcp_f32 v20, v18
    v_rcp_f32 v21, v19
    v_exp_f32 v98, v130
    v_exp_f32 v99, v131
    v_exp_f32 v100, v132
    v_exp_f32 v101, v133
    v_exp_f32 v102, v134
    v_exp_f32 v103, v135
    v_exp_f32 v104, v136
    v_exp_f32 v105, v137
    v_exp_f32 v106, v138
    v_exp_f32 v107, v139
    v_exp_f32 v108, v140
    v_exp_f32 v109, v141
    v_exp_f32 v110, v142
    v_exp_f32_e64 v111, v143
    v_pk_mul_f32 v[20:21], v[16:17], v[20:21]
    v_pk_add_f32 v[96:97], v[96:97], 1.0 op_sel_hi:[1,0]
    v_pk_add_f32 v[98:99], v[98:99], 1.0 op_sel_hi:[1,0]
    v_pk_add_f32 v[100:101], v[100:101], 1.0 op_sel_hi:[1,0]
    v_pk_add_f32 v[102:103], v[102:103], 1.0 op_sel_hi:[1,0]
    v_pk_add_f32 v[104:105], v[104:105], 1.0 op_sel_hi:[1,0]
    v_pk_add_f32 v[106:107], v[106:107], 1.0 op_sel_hi:[1,0]
    v_pk_add_f32 v[108:109], v[108:109], 1.0 op_sel_hi:[1,0]
    v_pk_add_f32 v[110:111], v[110:111], 1.0 op_sel_hi:[1,0]
    v_cvt_pk_bf16_f32 v88, v20, v21
    v_rcp_f32 v96, v96
    v_rcp_f32 v97, v97
    v_rcp_f32 v98, v98
    v_rcp_f32 v99, v99
    v_rcp_f32 v100, v100
    v_rcp_f32 v101, v101
    v_rcp_f32 v102, v102
    v_rcp_f32 v103, v103
    v_rcp_f32 v104, v104
    v_rcp_f32 v105, v105
    v_rcp_f32 v106, v106
    v_rcp_f32 v107, v107
    v_rcp_f32 v108, v108
    v_rcp_f32 v109, v109
    v_rcp_f32 v110, v110
    v_rcp_f32 v111, v111
    v_pk_mul_f32 v[16:17], v[128:129], v[96:97]
    v_pk_fma_f32 v[16:17], v[130:131], v[98:99], v[16:17]
    v_pk_fma_f32 v[16:17], v[132:133], v[100:101], v[16:17]
    v_pk_fma_f32 v[16:17], v[134:135], v[102:103], v[16:17]
    v_pk_fma_f32 v[16:17], v[136:137], v[104:105], v[16:17]
    v_pk_fma_f32 v[16:17], v[138:139], v[106:107], v[16:17]
    v_pk_fma_f32 v[16:17], v[140:141], v[108:109], v[16:17]
    v_pk_fma_f32 v[16:17], v[142:143], v[110:111], v[16:17]
    ds_read_b32 v76, v6
    v_rcp_f32 v20, v18
    v_rcp_f32 v21, v19
    v_mov_b32_e64 v77, 0
    v_mov_b32_e64 v78, 0
    v_mov_b32_e64 v79, 0
    v_pk_mul_f32 v[20:21], v[16:17], v[20:21]
    v_cvt_pk_bf16_f32 v92, v20, v21
    s_nop 0
    s_branch DRAIN
TAILS1:
    s_setprio 0
    s_nop 0
    ds_read_b64_tr_b16 v[32:33], v246 offset:0
    ds_read_b64_tr_b16 v[34:35], v246 offset:1024
    ds_read_b64_tr_b16 v[36:37], v246 offset:32
    ds_read_b64_tr_b16 v[38:39], v246 offset:1056
    ds_read_b64_tr_b16 v[40:41], v27 offset:0
    ds_read_b64_tr_b16 v[42:43], v27 offset:1024
    ds_read_b64_tr_b16 v[44:45], v27 offset:32
    ds_read_b64_tr_b16 v[46:47], v27 offset:1056
    ds_read_b64_tr_b16 v[48:49], v246 offset:4096
    ds_read_b64_tr_b16 v[50:51], v246 offset:5120
    ds_read_b64_tr_b16 v[52:53], v246 offset:4128
    ds_read_b64_tr_b16 v[54:55], v246 offset:5152
    ds_read_b64_tr_b16 v[56:57], v27 offset:4096
    ds_read_b64_tr_b16 v[58:59], v27 offset:5120
    ds_read_b64_tr_b16 v[60:61], v27 offset:4128
    ds_read_b64_tr_b16 v[62:63], v27 offset:5152
    ds_read_b64_tr_b16 v[144:145], v246 offset:8192
    ds_read_b64_tr_b16 v[146:147], v246 offset:9216
    ds_read_b64_tr_b16 v[148:149], v246 offset:8224
    ds_read_b64_tr_b16 v[150:151], v246 offset:9248
    ds_read_b64_tr_b16 v[152:153], v27 offset:8192
    ds_read_b64_tr_b16 v[154:155], v27 offset:9216
    ds_read_b64_tr_b16 v[156:157], v27 offset:8224
    ds_read_b64_tr_b16 v[158:159], v27 offset:9248
    ds_read_b64_tr_b16 v[160:161], v246 offset:12288
    ds_read_b64_tr_b16 v[162:163], v246 offset:13312
    ds_read_b64_tr_b16 v[164:165], v246 offset:12320
    ds_read_b64_tr_b16 v[166:167], v246 offset:13344
    ds_read_b64_tr_b16 v[168:169], v27 offset:12288
    ds_read_b64_tr_b16 v[170:171], v27 offset:13312
    ds_read_b64_tr_b16 v[172:173], v27 offset:12320
    ds_read_b64_tr_b16 v[174:175], v27 offset:13344
    v_exp_f32 v96, v128
    s_setprio 3
    v_exp_f32 v97, v129
    v_rcp_f32 v20, v18
    v_rcp_f32 v21, v19
    v_exp_f32 v98, v130
    v_exp_f32 v99, v131
    v_exp_f32 v100, v132
    v_exp_f32 v101, v133
    v_exp_f32 v102, v134
    v_exp_f32 v103, v135
    v_exp_f32 v104, v136
    v_exp_f32 v105, v137
    v_exp_f32 v106, v138
    v_exp_f32 v107, v139
    v_exp_f32 v108, v140
    v_exp_f32 v109, v141
    v_exp_f32 v110, v142
    v_exp_f32_e64 v111, v143
    v_pk_mul_f32 v[20:21], v[16:17], v[20:21]
    v_pk_add_f32 v[96:97], v[96:97], 1.0 op_sel_hi:[1,0]
    v_pk_add_f32 v[98:99], v[98:99], 1.0 op_sel_hi:[1,0]
    v_pk_add_f32 v[100:101], v[100:101], 1.0 op_sel_hi:[1,0]
    v_pk_add_f32 v[102:103], v[102:103], 1.0 op_sel_hi:[1,0]
    v_pk_add_f32 v[104:105], v[104:105], 1.0 op_sel_hi:[1,0]
    v_pk_add_f32 v[106:107], v[106:107], 1.0 op_sel_hi:[1,0]
    v_pk_add_f32 v[108:109], v[108:109], 1.0 op_sel_hi:[1,0]
    v_pk_add_f32 v[110:111], v[110:111], 1.0 op_sel_hi:[1,0]
    v_cvt_pk_bf16_f32 v89, v20, v21
    v_rcp_f32 v96, v96
    v_rcp_f32 v97, v97
    v_rcp_f32 v98, v98
    v_rcp_f32 v99, v99
    v_rcp_f32 v100, v100
    v_rcp_f32 v101, v101
    v_rcp_f32 v102, v102
    v_rcp_f32 v103, v103
    v_rcp_f32 v104, v104
    v_rcp_f32 v105, v105
    v_rcp_f32 v106, v106
    v_rcp_f32 v107, v107
    v_rcp_f32 v108, v108
    v_rcp_f32 v109, v109
    v_rcp_f32 v110, v110
    v_rcp_f32 v111, v111
    v_pk_mul_f32 v[16:17], v[128:129], v[96:97]
    v_pk_fma_f32 v[16:17], v[130:131], v[98:99], v[16:17]
    v_pk_fma_f32 v[16:17], v[132:133], v[100:101], v[16:17]
    v_pk_fma_f32 v[16:17], v[134:135], v[102:103], v[16:17]
    v_pk_fma_f32 v[16:17], v[136:137], v[104:105], v[16:17]
    v_pk_fma_f32 v[16:17], v[138:139], v[106:107], v[16:17]
    v_pk_fma_f32 v[16:17], v[140:141], v[108:109], v[16:17]
    v_pk_fma_f32 v[16:17], v[142:143], v[110:111], v[16:17]
    v_rcp_f32 v20, v18
    v_rcp_f32 v21, v19
    v_mov_b32_e64 v78, 0
    v_mov_b32_e64 v79, 0
    v_pk_mul_f32 v[20:21], v[16:17], v[20:21]
    v_cvt_pk_bf16_f32 v93, v20, v21
    s_nop 0
    s_branch DRAIN
R_SHRINK:
    s_lshr_b32 s64, s64, 2
    s_and_b32 s64, s64, -2
    s_max_u32 s64, s64, 2
    s_branch NEXT_ROUND
NEXTR:
    s_add_u32 s65, s65, s64
NEXT_ROUND:
    s_mov_b32 s70, 0x200000
    s_setprio 0
    s_waitcnt vmcnt(0) lgkmcnt(0)
    s_barrier
    v_lshlrev_b32_e64 v40, 4, v13
    v_add_u32 v41, 133888, v40
    v_mov_b32 v32, 0xf000
    v_mov_b32 v33, 0xf000
    v_mov_b32 v34, 0xf000
    v_mov_b32 v35, 0xf000
    ds_write_b128 v41, v[32:35] offset:0
    ds_write_b128 v41, v[32:35] offset:8192
    ds_write_b128 v41, v[32:35] offset:16384
    ds_write_b128 v41, v[32:35] offset:18208
    v_mov_b32 v36, 0
    v_mov_b32 v37, 0
    v_mov_b32 v38, 0
    v_mov_b32 v39, 0
    v_add_u32 v40, 73728, v40
    ds_write_b128 v40, v[36:39] offset:0
    ds_write_b128 v40, v[36:39] offset:8192
    ds_write_b128 v40, v[36:39] offset:16384
    v_min_u32 v40, 383, v13
    v_lshlrev_b32_e64 v40, 3, v40
    v_add_u32 v40, 98304, v40
    v_mov_b32 v42, 25872
    v_mov_b32 v43, 25872
    ds_write_b64 v40, v[42:43]
    s_waitcnt lgkmcnt(0)
    s_barrier
    s_cmp_eq_u32 s4, 1
    s_cbranch_scc0 STWB
    v_lshlrev_b32 v32, 2, v14
    v_mov_b32 v33, 0
    ds_write_b32 v32, v250 offset:2048
    ds_write_b32 v33, v33 offset:2304
    v_lshlrev_b32 v32, 2, v251
    v_add_u32 v32, 98304, v32
    v_lshrrev_b32 v33, 1, v251
    v_lshl_add_u32 v33, v33, 6, v249
    v_and_b32_e64 v34, 1, v251
    v_lshl_add_u32 v33, v34, 1, v33
    v_mov_b32 v34, 0x3f80
    s_mov_b32 exec_lo, 0x3cf3cf3c
    s_mov_b32 exec_hi, 0xf3cf
    ds_write_b32 v32, v247
    ds_write_b16 v33, v34
    s_mov_b64 exec, -1
STWB:
    v_mul_u32_u24 v33, 2176, v244
    s_lshr_b32 s5, s3, 2
    s_and_b32 s7, s3, 1
    s_lshl1_add_u32 s5, s5, s7
    s_and_b32 s7, s3, 2
    s_lshl_b32 s7, s7, 6
    s_add_u32 s5, s5, s7
    s_lshl3_add_u32 s5, s5, 3215360
    buffer_load_dwordx2 v[34:35], v33, s[44:47], s5 offen sc1
    s_waitcnt vmcnt(0) lgkmcnt(0)
    s_barrier
    s_branch POLL1
.set CODE_REST, K_END - CPF_PC
.section .rodata,"a"
.p2align 6
.amdhsa_kernel standalone__edge_featured_mpnn_mpnn__graph_kernel
  .amdhsa_next_free_vgpr 256
  .amdhsa_next_free_sgpr 102
  .amdhsa_accum_offset 256
  .amdhsa_group_segment_fixed_size 0
  .amdhsa_kernarg_size 88
  .amdhsa_user_sgpr_count 2
  .amdhsa_user_sgpr_kernarg_segment_ptr 1
  .amdhsa_system_sgpr_workgroup_id_x 1
.end_amdhsa_kernel
```
